```python
import torch

def _softmax(x, axis=-1):
    return torch.softmax(x, dim=axis)

def _gelu(x):
    return torch.nn.functional.gelu(x, approximate='tanh')

def _silu(x):
    return torch.nn.functional.silu(x)

def _sigmoid(x):
    return torch.sigmoid(x)

def _layernorm(x, axis=-1, eps=1e-05):
    m = x.mean(dim=axis, keepdim=True)
    v = x.var(dim=axis, keepdim=True, unbiased=False)
    return (x - m) / torch.sqrt(v + eps)

def _scatter_add(tgt, idx, src, axis=0):
    return tgt.clone().index_add_(axis, idx, src)

def _segment_sum(src, seg, n):
    out = torch.zeros((n,) + src.shape[1:], dtype=src.dtype)
    return out.index_add_(0, seg, src)

def _pad(x, pw):
    flat = tuple((v for pair in reversed(pw) for v in pair))
    return torch.nn.functional.pad(x, flat)
kernel_name = 'adaLN_cond__softmax_full_mha__dense_activation_silu__prompt'

def setup_inputs():

    _w = lambda a: (lambda t: t.to(torch.bfloat16) if t.is_floating_point() else t)(torch.as_tensor(a))

    def _A_setup():
        B, S, D = (1, 2048, 512)
        return {'x': _w((lambda *s: torch.randn(*s, dtype=torch.bfloat16) * 0.05)(B, S, D)), 'wqkv': _w((lambda *s: torch.randn(*s, dtype=torch.bfloat16) * 0.05)(D, 3 * D)), 'wo': _w((lambda *s: torch.randn(*s, dtype=torch.bfloat16) * 0.05)(D, D))}
    _A_in = _A_setup()

    def _B_setup():
        B, S, D, F = (1, 2048, 512, 1792)
        return {'x': _w((lambda *s: torch.randn(*s, dtype=torch.bfloat16) * 0.05)(B, S, D)), 'w1': _w((lambda *s: torch.randn(*s, dtype=torch.bfloat16) * 3.2)(D, F) * D ** (-0.5)), 'w2': _w((lambda *s: torch.randn(*s, dtype=torch.bfloat16) * 0.2)(F, D) * F ** (-0.5))}
    _B_in = _B_setup()
    return {'A_x': _A_in['x'], 'A_wqkv': _A_in['wqkv'], 'A_wo': _A_in['wo'], 'B_x': _B_in['x'], 'B_w1': _B_in['w1'], 'B_w2': _B_in['w2'], 'c': _w((lambda *s: torch.randn(*s, dtype=torch.bfloat16) * 0.1)(1, 512) * 8.0), 'w_mod': _w((lambda *s: torch.randn(*s, dtype=torch.bfloat16) * 0.1)(512, 6 * 512) * 512 ** (-0.5) * 8.0)}

def reference(A_x, A_wqkv, A_wo, B_x, B_w1, B_w2, c, w_mod):

    def _A_ref(x, wqkv, wo):
        B, S, D = x.shape
        H = 32
        Dh = D // H
        qkv = (lambda x, *d: x.permute(*d))((x @ wqkv).reshape(B, S, 3, H, Dh), 2, 0, 3, 1, 4)
        q, k, v = (qkv[0], qkv[1], qkv[2])
        scale = Dh ** (-0.5)
        scores = torch.einsum('bhqd,bhkd->bhqk', q, k) * scale
        p = _softmax(scores, axis=-1)
        o = torch.einsum('bhqk,bhkd->bhqd', p, v)
        return (lambda x, *d: x.permute(*d))(o, 0, 2, 1, 3).reshape(B, S, D) @ wo

    def _B_ref(x, w1, w2):
        h = torch.einsum('bsd,df->bsf', x, w1)
        h = _silu(h)
        out = torch.einsum('bsf,fd->bsd', h, w2)
        return out
    x = A_x
    mod = (_silu(c) @ w_mod).reshape(c.shape[0], 6, 1, -1)
    sa, ca, ga, sb, cb, gb = (mod[:, 0].clone(), mod[:, 1].clone(), mod[:, 2].clone(), mod[:, 3].clone(), mod[:, 4].clone(), mod[:, 5].clone())
    h = _layernorm(x, axis=-1) * (1 + ca) + sa
    x = x + ga * _A_ref(h, A_wqkv, A_wo)
    h = _layernorm(x, axis=-1) * (1 + cb) + sb
    x = x + gb * _B_ref(h, B_w1, B_w2)
    return x
```

```asm
; @launch grid=(256,1,1) block=(512,1,1) lds=163840
.amdgcn_target "amdgcn-amd-amdhsa--gfx950"
.text
.globl adaLN_cond__softmax_full_mha__dense_activation_silu__prompt_kernel
.p2align 8
.type adaLN_cond__softmax_full_mha__dense_activation_silu__prompt_kernel,@function
adaLN_cond__softmax_full_mha__dense_activation_silu__prompt_kernel:
    s_cmpk_ge_u32 s2, 256
    s_cbranch_scc1 L_end
    s_load_dwordx2 s[20:21], s[0:1], 56
    s_load_dwordx2 s[8:9], s[0:1], 80
    s_getpc_b64 s[44:45]
L_pc:
    v_lshlrev_b32 v126, 7, v0
    v_cmp_gt_u32 vcc, 64, v0
    s_and_saveexec_b64 s[46:47], vcc
    s_cbranch_execz L_nocode0
    global_load_dword v14, v126, s[44:45]
L_nocode0:
    s_load_dwordx2 s[16:17], s[0:1], 8
    s_load_dwordx2 s[24:25], s[0:1], 48
    s_load_dwordx2 s[12:13], s[0:1], 0
    s_mov_b64 exec, -1
    s_load_dwordx2 s[28:29], s[0:1], 64
    s_load_dwordx8 s[68:75], s[0:1], 16
    v_mov_b64 v[32:33], 0
    v_mov_b64 v[34:35], 0
    v_mov_b32 v36, 163776
    ds_write_b128 v36, v[32:35]
    ds_write_b128 v36, v[32:35] offset:16
    v_lshrrev_b32 v4, 6, v0
    v_and_b32 v1, 63, v0
    v_readfirstlane_b32 s3, v4
    s_lshr_b32 s6, s2, 3
    s_and_b32 s5, s2, 7
    s_lshr_b32 s35, s5, 2
    s_lshl_b32 s23, 1, 17
    s_mov_b32 s19, s23
    s_lshl_b32 s22, 3, 20
    s_lshl_b32 s18, 3, 19
    s_lshl_b32 s49, 1, 30
    s_movk_i32 s38, 3072
    s_lshr_b32 s33, s6, 3
    s_or_b32 s50, s33, s35
    v_and_b32 v6, 15, v1
    v_lshrrev_b32 v5, 4, v1
    v_mul_u32_u24 v6, s38, v6
    v_lshlrev_b32 v9, 6, v5
    v_add_lshl_u32 v15, v6, v9, 1
    v_lshl_add_u32 v6, v5, 10, v6
    s_lshl_b32 s39, s38, 4
    s_mul_i32 s39, s39, s6
    s_lshl_b32 s32, s5, 8
    s_add_u32 s40, s39, s32
    s_lshl_b32 s40, s40, 1
    s_xor_b32 s41, s3, 4
    s_or_b32 s41, s41, s35
    s_cselect_b32 s40, s49, s40
    s_and_b32 s32, s32, 0x300
    s_add_u32 s39, s39, s32
    s_sub_u32 s32, s3, 5
    s_lshl_b32 s41, s32, 7
    s_add_u32 s39, s39, s41
    s_cmp_lt_u32 s32, 2
    s_cselect_b32 s39, s39, s49
    s_cmp_lg_u32 s50, 0
    s_cselect_b32 s39, s39, s49
    s_waitcnt lgkmcnt(0)
    buffer_load_dword v14, v15, s[20:23], s40 offen
    s_load_dword s4, s[8:9], 0
    s_mov_b32 exec_hi, 0xffff
    buffer_load_dword v14, v6, s[16:19], s39 offen
    s_sub_u32 s39, s39, 786432
    s_xor_b32 s32, s33, 2
    s_or_b32 s32, s32, s35
    s_cselect_b32 s39, s49, s39
    buffer_load_dword v14, v6, s[16:19], s39 offen
    s_mov_b64 exec, -1
    s_mov_b32 s27, s23
    s_movk_i32 s26, 1024
    s_and_b32 s36, s3, 3
    s_cmp_eq_u32 s33, 1
    s_cselect_b32 s37, 0, s50
    s_lshr_b32 s32, s3, 2
    s_or_b32 s47, s37, s32
    v_lshlrev_b32 v3, 2, v1
    v_lshrrev_b32 v10, 2, v1
    v_and_b32 v11, 3, v1
    v_lshlrev_b32 v11, 4, v11
    v_mad_u32_u24 v5, v10, s38, v11
    s_lshl_b32 s41, s36, 8
    s_cmp_eq_u32 s47, 0
    s_cbranch_scc0 L_first
    v_mad_u32_u24 v4, v10, s38, v5
    s_lshl3_add_u32 s7, s5, s6
    s_mul_i32 s32, s33, 24
    s_add_u32 s7, s7, s32
    s_and_b32 s32, s6, 1
    s_lshl_b32 s32, s32, 2
    s_lshl3_add_u32 s32, s36, s32
    s_lshl_b32 s48, s32, 10
    s_mul_i32 s52, s48, 96
    s_lshl_b32 s32, s7, 6
    s_add_u32 s52, s52, s32
    buffer_load_dword v12, v3, s[24:27], s41 offen
    s_cmp_eq_u32 s50, 0
    s_cbranch_scc1 L_strip
    s_waitcnt vmcnt(0)
L_strip:
    s_add_u32 m0, s48, 98304
    s_add_u32 s39, s52, 0
    buffer_load_dwordx4 v4, s[20:23], s39 offen lds
    s_add_u32 m0, s48, 99328
    s_add_u32 s39, s52, 98304
    buffer_load_dwordx4 v4, s[20:23], s39 offen lds
    s_add_u32 m0, s48, 100352
    s_add_u32 s39, s52, 196608
    buffer_load_dwordx4 v4, s[20:23], s39 offen lds
    s_add_u32 m0, s48, 101376
    s_add_u32 s39, s52, 294912
    buffer_load_dwordx4 v4, s[20:23], s39 offen lds
    s_xor_b32 s32, s48, 4096
    s_sub_u32 s32, s32, s48
    s_sub_u32 s32, s32, 4096
    s_add_u32 s48, s48, s32
    s_mul_i32 s32, s32, 96
    s_add_u32 s52, s52, s32
    s_add_u32 m0, s48, 102400
    s_add_u32 s39, s52, 393216
    buffer_load_dwordx4 v4, s[20:23], s39 offen lds
    s_add_u32 m0, s48, 103424
    s_add_u32 s39, s52, 491520
    buffer_load_dwordx4 v4, s[20:23], s39 offen lds
    s_add_u32 m0, s48, 104448
    s_add_u32 s39, s52, 589824
    buffer_load_dwordx4 v4, s[20:23], s39 offen lds
    s_add_u32 m0, s48, 105472
    s_add_u32 s39, s52, 688128
    buffer_load_dwordx4 v4, s[20:23], s39 offen lds
    s_branch L_second
L_first:
    s_cmp_lt_u32 s3, 4
    s_cbranch_scc0 L_second
    s_cmp_eq_u32 s37, 0
    s_cbranch_scc1 L_second
    s_mov_b32 s15, s23
    s_lshl_b32 s14, 1, 21
    v_and_b32 v7, 7, v1
    v_lshrrev_b32 v8, 3, v1
    v_lshlrev_b32 v9, 10, v7
    v_lshl_add_u32 v9, v8, 4, v9
    s_lshl_b32 s32, s2, 13
    s_add_u32 s46, s32, s41
    buffer_load_dwordx4 v[16:19], v9, s[12:15], s46 offen
    buffer_load_dwordx4 v[20:23], v9, s[12:15], s46 offen offset:128
    s_lshl1_add_u32 s32, s33, 1
    s_sub_u32 s32, s32, s35
    s_cmp_ge_u32 s32, 5
    s_cselect_b32 s40, 0, s49
    s_add_u32 s32, s46, s40
    s_sub_u32 s32, s32, 1048576
    buffer_load_dwordx4 v[24:27], v9, s[12:15], s32 offen
    buffer_load_dwordx4 v[28:31], v9, s[12:15], s32 offen offset:128
L_second:
    v_lshlrev_b32 v126, 7, v1
    v_lshlrev_b32 v2, 4, v1
    s_and_b32 s57, s6, 7
    s_and_b32 s34, s5, 3
    s_lshl3_add_u32 s54, s35, s57
    s_lshl2_add_u32 s55, s34, s33
    s_lshl2_add_u32 s56, s5, s33
    s_mov_b32 s11, s23
    s_mov_b32 s15, s23
    s_mov_b32 s19, s23
    s_mov_b32 s31, s23
    s_lshl_b32 s10, 1, 28
    s_lshl_b32 s14, 1, 21
    s_lshl_b32 s18, 3, 19
    s_lshl_b32 s30, 1, 21
    s_barrier
    s_cmp_eq_u32 s47, 0
    s_cbranch_scc1 L_lo_strip
    s_cmp_lt_u32 s3, 4
    s_cbranch_scc1 L_lo_other
    s_mul_i32 s32, s6, 1152
    s_add_u32 s32, s32, 8192
    v_add_u32 v6, s32, v126
    v_cmp_gt_u32 vcc, L_codeend-L_pc, v6
    s_cmp_eq_u32 s3, 7
    s_cselect_b32 s32, 511, 0
    s_and_b32 exec_lo, vcc_lo, s32
    s_mov_b32 exec_hi, 0
    s_cbranch_execz L_nocode
    global_load_dword v14, v6, s[44:45]
L_nocode:
    s_mov_b64 exec, -1
    s_mov_b32 s45, s36
    s_lshl_b32 s39, s36, 10
    s_lshl_b32 s42, s55, 6
    s_cmp_lg_u32 s37, 0
    s_cbranch_scc1 L_hi_nojob
    v_mov_b32 v11, 163800
    s_mov_b32 s33, 0
L_spin_1:
    ds_read_b32 v10, v11
    s_add_u32 s33, s33, 1
    s_waitcnt lgkmcnt(0)
    v_readfirstlane_b32 s32, v10
    s_cmp_ge_u32 s32, 4
    s_cbranch_scc1 L_spun_2
    s_sleep 2
    s_cmp_lt_u32 s33, 400000
    s_cbranch_scc1 L_spin_1
L_spun_2:
L_hi_nojob:
    s_waitcnt vmcnt(0)
    s_and_b32 s45, s45, 31
    s_mul_i32 s38, s45, 49152
    s_add_u32 s38, s38, s42
    s_add_u32 s45, s45, 4
    s_add_u32 m0, s39, 0
    s_add_u32 s37, s38, 0
    buffer_load_dwordx4 v5, s[16:19], s37 offen lds
    s_add_u32 m0, s39, 32768
    s_add_u32 s37, s38, 1024
    buffer_load_dwordx4 v5, s[16:19], s37 offen lds
    s_add_u32 m0, s39, 65536
    s_add_u32 s37, s38, 2048
    buffer_load_dwordx4 v5, s[16:19], s37 offen lds
    s_and_b32 s45, s45, 31
    s_mul_i32 s38, s45, 49152
    s_add_u32 s38, s38, s42
    s_add_u32 s45, s45, 4
    s_add_u32 m0, s39, 4096
    s_add_u32 s37, s38, 0
    buffer_load_dwordx4 v5, s[16:19], s37 offen lds
    s_add_u32 m0, s39, 36864
    s_add_u32 s37, s38, 1024
    buffer_load_dwordx4 v5, s[16:19], s37 offen lds
    s_add_u32 m0, s39, 69632
    s_add_u32 s37, s38, 2048
    buffer_load_dwordx4 v5, s[16:19], s37 offen lds
    s_and_b32 s45, s45, 31
    s_mul_i32 s38, s45, 49152
    s_add_u32 s38, s38, s42
    s_add_u32 s45, s45, 4
    s_add_u32 m0, s39, 8192
    s_add_u32 s37, s38, 0
    buffer_load_dwordx4 v5, s[16:19], s37 offen lds
    s_add_u32 m0, s39, 40960
    s_add_u32 s37, s38, 1024
    buffer_load_dwordx4 v5, s[16:19], s37 offen lds
    s_add_u32 m0, s39, 73728
    s_add_u32 s37, s38, 2048
    buffer_load_dwordx4 v5, s[16:19], s37 offen lds
    s_and_b32 s45, s45, 31
    s_mul_i32 s38, s45, 49152
    s_add_u32 s38, s38, s42
    s_add_u32 s45, s45, 4
    s_add_u32 m0, s39, 12288
    s_add_u32 s37, s38, 0
    buffer_load_dwordx4 v5, s[16:19], s37 offen lds
    s_add_u32 m0, s39, 45056
    s_add_u32 s37, s38, 1024
    buffer_load_dwordx4 v5, s[16:19], s37 offen lds
    s_add_u32 m0, s39, 77824
    s_add_u32 s37, s38, 2048
    buffer_load_dwordx4 v5, s[16:19], s37 offen lds
    v_mov_b32 v11, 163804
    v_mov_b32 v10, 1
    s_mov_b64 exec, 1
    ds_add_u32 v11, v10
    s_mov_b64 exec, -1
    s_and_b32 s45, s45, 31
    s_mul_i32 s38, s45, 49152
    s_add_u32 s38, s38, s42
    s_add_u32 s45, s45, 4
    s_add_u32 m0, s39, 16384
    s_add_u32 s37, s38, 0
    buffer_load_dwordx4 v5, s[16:19], s37 offen lds
    s_add_u32 m0, s39, 49152
    s_add_u32 s37, s38, 1024
    buffer_load_dwordx4 v5, s[16:19], s37 offen lds
    s_add_u32 m0, s39, 81920
    s_add_u32 s37, s38, 2048
    buffer_load_dwordx4 v5, s[16:19], s37 offen lds
    s_and_b32 s45, s45, 31
    s_mul_i32 s38, s45, 49152
    s_add_u32 s38, s38, s42
    s_add_u32 s45, s45, 4
    s_add_u32 m0, s39, 20480
    s_add_u32 s37, s38, 0
    buffer_load_dwordx4 v5, s[16:19], s37 offen lds
    s_add_u32 m0, s39, 53248
    s_add_u32 s37, s38, 1024
    buffer_load_dwordx4 v5, s[16:19], s37 offen lds
    s_add_u32 m0, s39, 86016
    s_add_u32 s37, s38, 2048
    buffer_load_dwordx4 v5, s[16:19], s37 offen lds
    s_and_b32 s45, s45, 31
    s_mul_i32 s38, s45, 49152
    s_add_u32 s38, s38, s42
    s_add_u32 s45, s45, 4
    s_add_u32 m0, s39, 24576
    s_add_u32 s37, s38, 0
    buffer_load_dwordx4 v5, s[16:19], s37 offen lds
    s_add_u32 m0, s39, 57344
    s_add_u32 s37, s38, 1024
    buffer_load_dwordx4 v5, s[16:19], s37 offen lds
    s_add_u32 m0, s39, 90112
    s_add_u32 s37, s38, 2048
    buffer_load_dwordx4 v5, s[16:19], s37 offen lds
    s_and_b32 s45, s45, 31
    s_mul_i32 s38, s45, 49152
    s_add_u32 s38, s38, s42
    s_add_u32 s45, s45, 4
    s_add_u32 m0, s39, 28672
    s_add_u32 s37, s38, 0
    buffer_load_dwordx4 v5, s[16:19], s37 offen lds
    s_add_u32 m0, s39, 61440
    s_add_u32 s37, s38, 1024
    buffer_load_dwordx4 v5, s[16:19], s37 offen lds
    s_add_u32 m0, s39, 94208
    s_add_u32 s37, s38, 2048
    buffer_load_dwordx4 v5, s[16:19], s37 offen lds
    s_waitcnt lgkmcnt(0)
    s_mul_i32 s4, s4, 0x9e3779b1
    s_add_u32 s4, s4, 0x7f4a7c15
    s_waitcnt vmcnt(0)
    s_barrier
    s_branch L_p1_end
L_lo_strip:
    s_waitcnt lgkmcnt(0)
    s_mul_i32 s4, s4, 0x9e3779b1
    s_add_u32 s4, s4, 0x7f4a7c15
    s_waitcnt vmcnt(8)
    v_lshlrev_b32 v13, 16, v12
    v_and_b32 v14, 0xffff0000, v12
    v_mul_f32 v24, 0xbfb8aa3b, v13
    v_mul_f32 v25, 0xbfb8aa3b, v14
    v_exp_f32 v24, v24
    v_exp_f32 v25, v25
    s_lshl_b32 s32, s36, 8
    v_add_f32 v24, 1.0, v24
    v_add_f32 v25, 1.0, v25
    v_rcp_f32 v24, v24
    v_rcp_f32 v25, v25
    s_add_u32 s32, s32, 131072
    v_mul_f32 v13, v13, v24
    v_mul_f32 v14, v14, v25
    v_cvt_pk_bf16_f32 v13, v13, v14
    v_add_u32 v6, s32, v3
    ds_write_b32 v6, v13
    v_lshrrev_b32 v10, 5, v1
    v_lshl_add_u32 v6, v10, 4, s32
    s_waitcnt lgkmcnt(0)
    ds_read_b128 v[32:35], v6 offset:0
    ds_read_b128 v[36:39], v6 offset:32
    ds_read_b128 v[40:43], v6 offset:64
    ds_read_b128 v[44:47], v6 offset:96
    ds_read_b128 v[48:51], v6 offset:128
    ds_read_b128 v[52:55], v6 offset:160
    ds_read_b128 v[56:59], v6 offset:192
    ds_read_b128 v[60:63], v6 offset:224
    v_lshrrev_b32 v10, 5, v1
    v_lshlrev_b32 v5, 9, v10
    v_bfe_u32 v10, v1, 2, 2
    v_lshl_add_u32 v5, v10, 6, v5
    v_bfe_u32 v10, v1, 4, 1
    v_lshl_add_u32 v5, v10, 5, v5
    v_and_b32 v10, 3, v1
    v_lshl_add_u32 v5, v10, 3, v5
    s_lshl_b32 s32, s36, 13
    s_add_u32 s32, s32, 98304
    v_add_u32 v5, s32, v5
    s_waitcnt vmcnt(0) lgkmcnt(0)
    ds_read_b64_tr_b16 v[64:65], v5 offset:0
    ds_read_b64_tr_b16 v[66:67], v5 offset:256
    ds_read_b64_tr_b16 v[68:69], v5 offset:1024
    ds_read_b64_tr_b16 v[70:71], v5 offset:1280
    ds_read_b64_tr_b16 v[72:73], v5 offset:2048
    ds_read_b64_tr_b16 v[74:75], v5 offset:2304
    ds_read_b64_tr_b16 v[76:77], v5 offset:3072
    ds_read_b64_tr_b16 v[78:79], v5 offset:3328
    ds_read_b64_tr_b16 v[80:81], v5 offset:4096
    ds_read_b64_tr_b16 v[82:83], v5 offset:4352
    ds_read_b64_tr_b16 v[84:85], v5 offset:5120
    ds_read_b64_tr_b16 v[86:87], v5 offset:5376
    s_waitcnt lgkmcnt(4)
    ds_read_b64_tr_b16 v[88:89], v5 offset:6144
    ds_read_b64_tr_b16 v[90:91], v5 offset:6400
    ds_read_b64_tr_b16 v[92:93], v5 offset:7168
    ds_read_b64_tr_b16 v[94:95], v5 offset:7424
    v_mfma_f32_32x32x16_bf16 v[96:111], v[32:35], v[64:67], 0
    v_mfma_f32_32x32x16_bf16 v[96:111], v[36:39], v[68:71], v[96:111]
    v_mfma_f32_32x32x16_bf16 v[96:111], v[40:43], v[72:75], v[96:111]
    v_mfma_f32_32x32x16_bf16 v[96:111], v[44:47], v[76:79], v[96:111]
    s_waitcnt lgkmcnt(0)
    v_mfma_f32_32x32x16_bf16 v[96:111], v[48:51], v[80:83], v[96:111]
    v_mfma_f32_32x32x16_bf16 v[96:111], v[52:55], v[84:87], v[96:111]
    v_mfma_f32_32x32x16_bf16 v[96:111], v[56:59], v[88:91], v[96:111]
    v_mfma_f32_32x32x16_bf16 v[96:111], v[60:63], v[92:95], v[96:111]
    v_mov_b32 v11, 163800
    v_mov_b32 v10, 1
    s_mov_b64 exec, 1
    ds_add_u32 v11, v10
    s_mov_b64 exec, -1
    v_and_b32 v5, 0x7c, v3
    v_add_u32 v5, 132096, v5
    s_lshl_b32 s32, s36, 7
    v_add_u32 v6, s32, v5
    s_nop 7
    ds_write_b32 v6, v96
    v_mov_b32 v11, 163780
    v_mov_b32 v10, 1
    s_mov_b64 exec, 1
    ds_add_rtn_u32 v10, v11, v10
    s_mov_b64 exec, -1
    s_waitcnt lgkmcnt(0)
    v_readfirstlane_b32 s32, v10
    s_cmp_lg_u32 s32, 3
    s_cbranch_scc1 L_lo_nofh
    ds_read_b32 v100, v5
    ds_read_b32 v101, v5 offset:128
    ds_read_b32 v102, v5 offset:256
    ds_read_b32 v103, v5 offset:384
    s_lshr_b32 s32, s7, 4
    s_cmp_eq_u32 s32, 1
    s_cselect_b32 s33, 1.0, 0
    s_cmp_eq_u32 s32, 4
    s_cselect_b32 s33, 1.0, s33
    s_waitcnt lgkmcnt(0)
    v_add_f32 v100, v100, v101
    v_add_f32 v102, v102, v103
    v_add_f32 v100, v100, v102
    v_cvt_pk_bf16_f32 v100, v100, v100
    v_and_b32 v100, 0xffff0000, v100
    v_add_f32 v100, s33, v100
    s_lshl_b32 s32, s7, 7
    s_add_u32 s32, s32, 16384
    v_mov_b32_dpp v101, v100 quad_perm:[1,0,3,2] row_mask:0xf bank_mask:0xf
    v_cvt_pk_bf16_f32 v100, v100, v101
    v_mov_b32 v101, s4
    s_mov_b64 exec, 0x55555555
    buffer_store_dwordx2 v[100:101], v3, s[8:11], s32 offen sc1
    s_mov_b64 exec, -1
    s_branch L_lo_nofh
L_lo_other:
    s_waitcnt lgkmcnt(0)
    s_mul_i32 s4, s4, 0x9e3779b1
    s_add_u32 s4, s4, 0x7f4a7c15
    s_cmp_eq_u32 s37, 0
    s_cbranch_scc1 L_lo_nofh
    v_lshlrev_b32 v5, 5, v7
    v_add_u32 v5, 133120, v5
    v_bfe_u32 v10, v1, 4, 1
    v_lshl_add_u32 v6, v10, 4, v5
    s_lshl_b32 s32, s3, 2
    v_add_u32 v6, s32, v6
    s_mov_b32 s32, 0x3f803f80
    v_mov_b64 v[84:85], 0
    v_mov_b64 v[86:87], 0
    s_waitcnt vmcnt(0)
    v_dot2_f32_bf16 v84, v16, s32, v84
    v_dot2_f32_bf16 v85, v16, v16, v85
    v_dot2_f32_bf16 v86, v24, s32, v86
    v_dot2_f32_bf16 v87, v24, v24, v87
    v_dot2_f32_bf16 v84, v17, s32, v84
    v_dot2_f32_bf16 v85, v17, v17, v85
    v_dot2_f32_bf16 v86, v25, s32, v86
    v_dot2_f32_bf16 v87, v25, v25, v87
    v_dot2_f32_bf16 v84, v18, s32, v84
    v_dot2_f32_bf16 v85, v18, v18, v85
    v_dot2_f32_bf16 v86, v26, s32, v86
    v_dot2_f32_bf16 v87, v26, v26, v87
    v_dot2_f32_bf16 v84, v19, s32, v84
    v_dot2_f32_bf16 v85, v19, v19, v85
    v_dot2_f32_bf16 v86, v27, s32, v86
    v_dot2_f32_bf16 v87, v27, v27, v87
    v_dot2_f32_bf16 v84, v20, s32, v84
    v_dot2_f32_bf16 v85, v20, v20, v85
    v_dot2_f32_bf16 v86, v28, s32, v86
    v_dot2_f32_bf16 v87, v28, v28, v87
    v_dot2_f32_bf16 v84, v21, s32, v84
    v_dot2_f32_bf16 v85, v21, v21, v85
    v_dot2_f32_bf16 v86, v29, s32, v86
    v_dot2_f32_bf16 v87, v29, v29, v87
    v_dot2_f32_bf16 v84, v22, s32, v84
    v_dot2_f32_bf16 v85, v22, v22, v85
    v_dot2_f32_bf16 v86, v30, s32, v86
    v_dot2_f32_bf16 v87, v30, v30, v87
    v_dot2_f32_bf16 v84, v23, s32, v84
    v_dot2_f32_bf16 v85, v23, v23, v85
    v_dot2_f32_bf16 v86, v31, s32, v86
    v_dot2_f32_bf16 v87, v31, v31, v87
    s_nop 2
    v_add_f32_dpp v84, v84, v84 row_ror:8 row_mask:0xf bank_mask:0xf
    v_add_f32_dpp v85, v85, v85 row_ror:8 row_mask:0xf bank_mask:0xf
    s_nop 1
    v_permlane16_swap_b32 v84, v85
    v_add_f32 v84, v84, v85
    v_mov_b32 v85, v84
    s_nop 1
    v_permlane32_swap_b32 v84, v85
    v_add_f32 v84, v84, v85
    ds_write_b32 v6, v84 offset:0
    s_nop 2
    v_add_f32_dpp v86, v86, v86 row_ror:8 row_mask:0xf bank_mask:0xf
    v_add_f32_dpp v87, v87, v87 row_ror:8 row_mask:0xf bank_mask:0xf
    s_nop 1
    v_permlane16_swap_b32 v86, v87
    v_add_f32 v86, v86, v87
    v_mov_b32 v87, v86
    s_nop 1
    v_permlane32_swap_b32 v86, v87
    v_add_f32 v86, v86, v87
    ds_write_b32 v6, v86 offset:256
    v_mov_b32 v11, 163776
    v_mov_b32 v10, 1
    s_mov_b64 exec, 1
    ds_add_u32 v11, v10
    s_mov_b64 exec, -1
    v_lshlrev_b32 v9, 9, v8
    v_lshl_add_u32 v9, v7, 4, v9
    s_lshr_b32 s32, s2, 2
    s_lshl_b32 s32, s32, 15
    s_lshl_b32 s33, s3, 13
    s_add_u32 s32, s32, s33
    s_and_b32 s33, s2, 3
    s_lshl_b32 s33, s33, 7
    s_add_u32 s32, s32, s33
    s_add_u32 s37, s32, 1048576
    s_add_u32 s38, s37, 4096
    s_add_u32 s44, s37, s40
    s_sub_u32 s44, s44, 1048576
    s_add_u32 s45, s44, 4096
    s_lshl_b32 s32, s2, 7
    s_add_u32 s39, s32, 65536
    s_add_u32 s46, s39, s40
    s_sub_u32 s46, s46, 16384
    v_lshlrev_b32 v32, 16, v16
    v_and_b32 v33, 0xffff0000, v16
    v_lshlrev_b32 v34, 16, v17
    v_and_b32 v35, 0xffff0000, v17
    v_lshlrev_b32 v36, 16, v18
    v_and_b32 v37, 0xffff0000, v18
    v_lshlrev_b32 v38, 16, v19
    v_and_b32 v39, 0xffff0000, v19
    v_lshlrev_b32 v40, 16, v20
    v_and_b32 v41, 0xffff0000, v20
    v_lshlrev_b32 v42, 16, v21
    v_and_b32 v43, 0xffff0000, v21
    v_lshlrev_b32 v44, 16, v22
    v_and_b32 v45, 0xffff0000, v22
    v_lshlrev_b32 v46, 16, v23
    v_and_b32 v47, 0xffff0000, v23
    v_lshlrev_b32 v48, 16, v24
    v_and_b32 v49, 0xffff0000, v24
    v_lshlrev_b32 v50, 16, v25
    v_and_b32 v51, 0xffff0000, v25
    v_lshlrev_b32 v52, 16, v26
    v_and_b32 v53, 0xffff0000, v26
    v_lshlrev_b32 v54, 16, v27
    v_and_b32 v55, 0xffff0000, v27
    v_lshlrev_b32 v56, 16, v28
    v_and_b32 v57, 0xffff0000, v28
    v_lshlrev_b32 v58, 16, v29
    v_and_b32 v59, 0xffff0000, v29
    v_lshlrev_b32 v60, 16, v30
    v_and_b32 v61, 0xffff0000, v30
    v_lshlrev_b32 v62, 16, v31
    v_and_b32 v63, 0xffff0000, v31
    v_mov_b32 v11, 163776
    s_mov_b32 s33, 0
L_spin_3:
    ds_read_b32 v10, v11
    s_add_u32 s33, s33, 1
    s_waitcnt lgkmcnt(0)
    v_readfirstlane_b32 s32, v10
    s_cmp_ge_u32 s32, 4
    s_cbranch_scc1 L_spun_4
    s_cmp_lt_u32 s33, 400000
    s_cbranch_scc1 L_spin_3
L_spun_4:
    ds_read_b128 v[64:67], v5 offset:0
    ds_read_b128 v[68:71], v5 offset:16
    ds_read_b128 v[72:75], v5 offset:256
    ds_read_b128 v[76:79], v5 offset:272
    s_waitcnt lgkmcnt(0)
    v_add_f32 v64, v64, v65
    v_add_f32 v66, v66, v67
    v_add_f32 v68, v68, v69
    v_add_f32 v70, v70, v71
    v_add_f32 v64, v64, v66
    v_add_f32 v68, v68, v70
    v_mul_f32 v64, 0x3b000000, v64
    v_mul_f32 v68, 0x3b000000, v68
    v_fma_f32 v68, -v64, v64, v68
    v_max_f32 v68, 0, v68
    v_add_f32 v68, 0x3727c5ac, v68
    v_rsq_f32 v68, v68
    s_nop 0
    v_mul_f32 v64, v64, v68
    v_fma_f32 v32, v32, v68, -v64
    v_fma_f32 v33, v33, v68, -v64
    v_fma_f32 v34, v34, v68, -v64
    v_fma_f32 v35, v35, v68, -v64
    v_fma_f32 v36, v36, v68, -v64
    v_fma_f32 v37, v37, v68, -v64
    v_fma_f32 v38, v38, v68, -v64
    v_fma_f32 v39, v39, v68, -v64
    v_fma_f32 v40, v40, v68, -v64
    v_fma_f32 v41, v41, v68, -v64
    v_fma_f32 v42, v42, v68, -v64
    v_fma_f32 v43, v43, v68, -v64
    v_fma_f32 v44, v44, v68, -v64
    v_fma_f32 v45, v45, v68, -v64
    v_fma_f32 v46, v46, v68, -v64
    v_fma_f32 v47, v47, v68, -v64
    v_add_f32 v72, v72, v73
    v_add_f32 v74, v74, v75
    v_add_f32 v76, v76, v77
    v_add_f32 v78, v78, v79
    v_add_f32 v72, v72, v74
    v_add_f32 v76, v76, v78
    v_mul_f32 v72, 0x3b000000, v72
    v_mul_f32 v76, 0x3b000000, v76
    v_fma_f32 v76, -v72, v72, v76
    v_max_f32 v76, 0, v76
    v_add_f32 v76, 0x3727c5ac, v76
    v_rsq_f32 v76, v76
    s_nop 0
    v_mul_f32 v72, v72, v76
    v_fma_f32 v48, v48, v76, -v72
    v_fma_f32 v49, v49, v76, -v72
    v_fma_f32 v50, v50, v76, -v72
    v_fma_f32 v51, v51, v76, -v72
    v_fma_f32 v52, v52, v76, -v72
    v_fma_f32 v53, v53, v76, -v72
    v_fma_f32 v54, v54, v76, -v72
    v_fma_f32 v55, v55, v76, -v72
    v_fma_f32 v56, v56, v76, -v72
    v_fma_f32 v57, v57, v76, -v72
    v_fma_f32 v58, v58, v76, -v72
    v_fma_f32 v59, v59, v76, -v72
    v_fma_f32 v60, v60, v76, -v72
    v_fma_f32 v61, v61, v76, -v72
    v_fma_f32 v62, v62, v76, -v72
    v_fma_f32 v63, v63, v76, -v72
    v_lshrrev_b32 v10, 5, v1
    v_mul_u32_u24 v10, 1536, v10
    v_add_u32 v6, v10, v2
    s_lshl_b32 s43, s3, 9
    s_add_u32 s42, s43, 135168
    s_add_u32 s43, s43, 16384
    v_lshl_add_u32 v4, v1, 3, s42
    v_lshl_add_u32 v5, v8, 4, s42
    v_mov_b32 v11, 163804
    s_mov_b32 s33, 0
L_spin_7:
    ds_read_b32 v10, v11
    s_add_u32 s33, s33, 1
    s_waitcnt lgkmcnt(0)
    v_readfirstlane_b32 s32, v10
    s_cmp_ge_u32 s32, 4
    s_cbranch_scc1 L_spun_8
    s_sleep 1
    s_cmp_lt_u32 s33, 400000
    s_cbranch_scc1 L_spin_7
L_spun_8:
    s_mov_b32 s33, 0
L_pollm_5:
    buffer_load_dwordx4 v[64:67], v6, s[8:11], s43 offen sc1
    s_waitcnt vmcnt(0)
    v_cmp_ne_u32 vcc, s4, v65
    v_cmp_ne_u32 s[34:35], s4, v67
    s_or_b64 vcc, vcc, s[34:35]
    s_cbranch_vccz L_gotm_6
    s_sleep 4
    s_add_u32 s33, s33, 1
    s_cmp_lt_u32 s33, 100000
    s_cbranch_scc1 L_pollm_5
L_gotm_6:
    v_mov_b32 v65, v66
    ds_write_b64 v4, v[64:65]
    ds_read_b128 v[68:71], v5 offset:256
    ds_read_b128 v[76:79], v5
    ds_read_b128 v[72:75], v5 offset:384
    ds_read_b128 v[80:83], v5 offset:128
    s_waitcnt lgkmcnt(2)
    v_lshlrev_b32 v84, 16, v68
    v_and_b32 v85, 0xffff0000, v68
    v_lshlrev_b32 v86, 16, v76
    v_and_b32 v87, 0xffff0000, v76
    v_pk_fma_f32 v[88:89], v[32:33], v[84:85], v[86:87]
    v_pk_fma_f32 v[90:91], v[48:49], v[84:85], v[86:87]
    v_cvt_pk_bf16_f32 v16, v88, v89
    v_cvt_pk_bf16_f32 v24, v90, v91
    v_lshlrev_b32 v84, 16, v69
    v_and_b32 v85, 0xffff0000, v69
    v_lshlrev_b32 v86, 16, v77
    v_and_b32 v87, 0xffff0000, v77
    v_pk_fma_f32 v[88:89], v[34:35], v[84:85], v[86:87]
    v_pk_fma_f32 v[90:91], v[50:51], v[84:85], v[86:87]
    v_cvt_pk_bf16_f32 v17, v88, v89
    v_cvt_pk_bf16_f32 v25, v90, v91
    v_lshlrev_b32 v84, 16, v70
    v_and_b32 v85, 0xffff0000, v70
    v_lshlrev_b32 v86, 16, v78
    v_and_b32 v87, 0xffff0000, v78
    v_pk_fma_f32 v[88:89], v[36:37], v[84:85], v[86:87]
    v_pk_fma_f32 v[90:91], v[52:53], v[84:85], v[86:87]
    v_cvt_pk_bf16_f32 v18, v88, v89
    v_cvt_pk_bf16_f32 v26, v90, v91
    v_lshlrev_b32 v84, 16, v71
    v_and_b32 v85, 0xffff0000, v71
    v_lshlrev_b32 v86, 16, v79
    v_and_b32 v87, 0xffff0000, v79
    v_pk_fma_f32 v[88:89], v[38:39], v[84:85], v[86:87]
    v_pk_fma_f32 v[90:91], v[54:55], v[84:85], v[86:87]
    v_cvt_pk_bf16_f32 v19, v88, v89
    v_cvt_pk_bf16_f32 v27, v90, v91
    buffer_store_dwordx4 v[16:19], v9, s[8:11], s37 offen sc1
    buffer_store_dwordx4 v[24:27], v9, s[8:11], s44 offen sc1
    s_waitcnt lgkmcnt(0)
    v_lshlrev_b32 v84, 16, v72
    v_and_b32 v85, 0xffff0000, v72
    v_lshlrev_b32 v86, 16, v80
    v_and_b32 v87, 0xffff0000, v80
    v_pk_fma_f32 v[88:89], v[40:41], v[84:85], v[86:87]
    v_pk_fma_f32 v[90:91], v[56:57], v[84:85], v[86:87]
    v_cvt_pk_bf16_f32 v20, v88, v89
    v_cvt_pk_bf16_f32 v28, v90, v91
    v_lshlrev_b32 v84, 16, v73
    v_and_b32 v85, 0xffff0000, v73
    v_lshlrev_b32 v86, 16, v81
    v_and_b32 v87, 0xffff0000, v81
    v_pk_fma_f32 v[88:89], v[42:43], v[84:85], v[86:87]
    v_pk_fma_f32 v[90:91], v[58:59], v[84:85], v[86:87]
    v_cvt_pk_bf16_f32 v21, v88, v89
    v_cvt_pk_bf16_f32 v29, v90, v91
    v_lshlrev_b32 v84, 16, v74
    v_and_b32 v85, 0xffff0000, v74
    v_lshlrev_b32 v86, 16, v82
    v_and_b32 v87, 0xffff0000, v82
    v_pk_fma_f32 v[88:89], v[44:45], v[84:85], v[86:87]
    v_pk_fma_f32 v[90:91], v[60:61], v[84:85], v[86:87]
    v_cvt_pk_bf16_f32 v22, v88, v89
    v_cvt_pk_bf16_f32 v30, v90, v91
    v_lshlrev_b32 v84, 16, v75
    v_and_b32 v85, 0xffff0000, v75
    v_lshlrev_b32 v86, 16, v83
    v_and_b32 v87, 0xffff0000, v83
    v_pk_fma_f32 v[88:89], v[46:47], v[84:85], v[86:87]
    v_pk_fma_f32 v[90:91], v[62:63], v[84:85], v[86:87]
    v_cvt_pk_bf16_f32 v23, v88, v89
    v_cvt_pk_bf16_f32 v31, v90, v91
    buffer_store_dwordx4 v[20:23], v9, s[8:11], s38 offen sc1
    buffer_store_dwordx4 v[28:31], v9, s[8:11], s45 offen sc1
    s_waitcnt vmcnt(0)
    v_mov_b32 v11, 163788
    v_mov_b32 v10, 1
    s_mov_b64 exec, 1
    ds_add_rtn_u32 v10, v11, v10
    s_mov_b64 exec, -1
    s_waitcnt lgkmcnt(0)
    v_readfirstlane_b32 s32, v10
    s_cmp_lg_u32 s32, 3
    s_cbranch_scc1 L_lo_nofh
    v_mov_b32 v10, s4
    s_mov_b64 exec, 1
    buffer_store_dword v10, v3, s[8:11], s39 offen sc1
    s_mov_b64 exec, -1
    v_mov_b32 v10, s4
    s_mov_b64 exec, 1
    buffer_store_dword v10, v3, s[8:11], s46 offen sc1
    s_mov_b64 exec, -1
L_lo_nofh:
    s_lshl2_add_u32 s36, s54, s3
    s_lshl_b32 s37, s36, 9
    s_add_u32 s37, s37, 65536
    s_lshl_b32 s32, s55, 17
    s_lshl_b32 s33, s36, 10
    s_add_u32 s32, s32, s33
    s_add_u32 s78, s32, 3145728
    s_add_u32 s79, s32, 3211264
    s_add_u32 s80, s32, 5242880
    s_add_u32 s81, s32, 5308416
    s_add_u32 s84, s32, 7340032
    s_mov_b32 s85, 0x3eb8aa3b
    v_and_b32 v7, 0x33, v1
    v_bfe_u32 v8, v1, 2, 1
    v_lshl_or_b32 v7, v8, 3, v7
    v_bfe_u32 v8, v1, 3, 1
    v_lshl_or_b32 v7, v8, 2, v7
    v_lshlrev_b32 v7, 4, v7
    v_bfe_u32 v8, v1, 4, 1
    v_lshlrev_b32 v8, 16, v8
    v_lshrrev_b32 v9, 5, v1
    v_lshl_add_u32 v8, v9, 8, v8
    v_and_b32 v9, 15, v1
    v_lshl_add_u32 v8, v9, 4, v8
    s_lshl_b32 s67, s55, 4
    s_add_u32 s67, s67, s54
    s_lshl_b32 s67, s67, 7
    s_add_u32 s67, s67, 98304
    s_barrier
    s_mov_b32 exec_lo, 0xf
    s_mov_b32 exec_hi, 0x0
    s_mov_b32 s33, 0
L_poll_9:
    buffer_load_dword v10, v126, s[8:11], s37 offen sc1
    s_waitcnt vmcnt(0)
    v_cmp_ne_u32 vcc, s4, v10
    s_cbranch_vccz L_got_10
    s_add_u32 s33, s33, 1
    s_cmp_lt_u32 s33, 100000
    s_cbranch_scc1 L_poll_9
L_got_10:
    s_mov_b64 exec, -1
    s_lshl_b32 s38, s36, 15
    s_add_u32 s38, s38, 1048576
    s_mov_b32 s39, 0
    s_and_b32 s39, s39, 32767
    s_add_u32 s32, s38, s39
    s_add_u32 s39, s39, 4096
    buffer_load_dwordx4 a[0:3], v2, s[8:11], s32 offen offset:0 sc1
    buffer_load_dwordx4 a[4:7], v2, s[8:11], s32 offen offset:1024 sc1
    buffer_load_dwordx4 a[8:11], v2, s[8:11], s32 offen offset:2048 sc1
    buffer_load_dwordx4 a[12:15], v2, s[8:11], s32 offen offset:3072 sc1
    s_and_b32 s39, s39, 32767
    s_add_u32 s32, s38, s39
    s_add_u32 s39, s39, 4096
    buffer_load_dwordx4 a[16:19], v2, s[8:11], s32 offen offset:0 sc1
    buffer_load_dwordx4 a[20:23], v2, s[8:11], s32 offen offset:1024 sc1
    buffer_load_dwordx4 a[24:27], v2, s[8:11], s32 offen offset:2048 sc1
    buffer_load_dwordx4 a[28:31], v2, s[8:11], s32 offen offset:3072 sc1
    v_lshrrev_b32 v10, 5, v1
    v_lshlrev_b32 v5, 9, v10
    v_bfe_u32 v10, v1, 2, 2
    v_lshl_add_u32 v5, v10, 6, v5
    v_bfe_u32 v10, v1, 4, 1
    v_lshl_add_u32 v5, v10, 5, v5
    v_and_b32 v10, 3, v1
    v_lshl_add_u32 v5, v10, 3, v5
    v_add_u32 v6, 65536, v5
    ds_read_b64_tr_b16 v[12:13], v5 offset:0
    ds_read_b64_tr_b16 v[14:15], v5 offset:256
    ds_read_b64_tr_b16 v[16:17], v5 offset:32768
    ds_read_b64_tr_b16 v[18:19], v5 offset:33024
    ds_read_b64_tr_b16 v[20:21], v6 offset:0
    ds_read_b64_tr_b16 v[22:23], v6 offset:256
    ds_read_b64_tr_b16 v[24:25], v5 offset:1024
    ds_read_b64_tr_b16 v[26:27], v5 offset:1280
    ds_read_b64_tr_b16 v[28:29], v5 offset:33792
    ds_read_b64_tr_b16 v[30:31], v5 offset:34048
    ds_read_b64_tr_b16 v[32:33], v6 offset:1024
    ds_read_b64_tr_b16 v[34:35], v6 offset:1280
    s_waitcnt vmcnt(7) lgkmcnt(10)
    v_mfma_f32_32x32x16_bf16 v[48:63], v[12:15], a[0:3], 0
    ds_read_b64_tr_b16 v[36:37], v5 offset:2048
    ds_read_b64_tr_b16 v[38:39], v5 offset:2304
    s_waitcnt lgkmcnt(10)
    v_mfma_f32_32x32x16_bf16 v[64:79], v[16:19], a[0:3], 0
    ds_read_b64_tr_b16 v[40:41], v5 offset:34816
    ds_read_b64_tr_b16 v[42:43], v5 offset:35072
    s_waitcnt lgkmcnt(10)
    v_mfma_f32_32x32x16_bf16 v[80:95], a[0:3], v[20:23], 0
    ds_read_b64_tr_b16 v[44:45], v6 offset:2048
    ds_read_b64_tr_b16 v[46:47], v6 offset:2304
    s_and_b32 s39, s39, 32767
    s_add_u32 s32, s38, s39
    s_add_u32 s39, s39, 4096
    buffer_load_dwordx4 a[32:35], v2, s[8:11], s32 offen offset:0 sc1
    s_waitcnt vmcnt(7) lgkmcnt(10)
    v_mfma_f32_32x32x16_bf16 v[48:63], v[24:27], a[4:7], v[48:63]
    ds_read_b64_tr_b16 v[12:13], v5 offset:3072
    ds_read_b64_tr_b16 v[14:15], v5 offset:3328
    s_waitcnt lgkmcnt(10)
    v_mfma_f32_32x32x16_bf16 v[64:79], v[28:31], a[4:7], v[64:79]
    ds_read_b64_tr_b16 v[16:17], v5 offset:35840
    ds_read_b64_tr_b16 v[18:19], v5 offset:36096
    s_waitcnt lgkmcnt(10)
    v_mfma_f32_32x32x16_bf16 v[80:95], a[4:7], v[32:35], v[80:95]
    ds_read_b64_tr_b16 v[20:21], v6 offset:3072
    ds_read_b64_tr_b16 v[22:23], v6 offset:3328
    buffer_load_dwordx4 a[36:39], v2, s[8:11], s32 offen offset:1024 sc1
    s_waitcnt vmcnt(7) lgkmcnt(10)
    v_mfma_f32_32x32x16_bf16 v[48:63], v[36:39], a[8:11], v[48:63]
    ds_read_b64_tr_b16 v[24:25], v5 offset:4096
    ds_read_b64_tr_b16 v[26:27], v5 offset:4352
    s_waitcnt lgkmcnt(10)
    v_mfma_f32_32x32x16_bf16 v[64:79], v[40:43], a[8:11], v[64:79]
    ds_read_b64_tr_b16 v[28:29], v5 offset:36864
    ds_read_b64_tr_b16 v[30:31], v5 offset:37120
    s_waitcnt lgkmcnt(10)
    v_mfma_f32_32x32x16_bf16 v[80:95], a[8:11], v[44:47], v[80:95]
    ds_read_b64_tr_b16 v[32:33], v6 offset:4096
    ds_read_b64_tr_b16 v[34:35], v6 offset:4352
    buffer_load_dwordx4 a[40:43], v2, s[8:11], s32 offen offset:2048 sc1
    s_waitcnt vmcnt(7) lgkmcnt(10)
    v_mfma_f32_32x32x16_bf16 v[48:63], v[12:15], a[12:15], v[48:63]
    ds_read_b64_tr_b16 v[36:37], v5 offset:5120
    ds_read_b64_tr_b16 v[38:39], v5 offset:5376
    s_waitcnt lgkmcnt(10)
    v_mfma_f32_32x32x16_bf16 v[64:79], v[16:19], a[12:15], v[64:79]
    ds_read_b64_tr_b16 v[40:41], v5 offset:37888
    ds_read_b64_tr_b16 v[42:43], v5 offset:38144
    s_waitcnt lgkmcnt(10)
    v_mfma_f32_32x32x16_bf16 v[80:95], a[12:15], v[20:23], v[80:95]
    ds_read_b64_tr_b16 v[44:45], v6 offset:5120
    ds_read_b64_tr_b16 v[46:47], v6 offset:5376
    buffer_load_dwordx4 a[44:47], v2, s[8:11], s32 offen offset:3072 sc1
    s_waitcnt vmcnt(7) lgkmcnt(10)
    v_mfma_f32_32x32x16_bf16 v[48:63], v[24:27], a[16:19], v[48:63]
    ds_read_b64_tr_b16 v[12:13], v5 offset:6144
    ds_read_b64_tr_b16 v[14:15], v5 offset:6400
    s_waitcnt lgkmcnt(10)
    v_mfma_f32_32x32x16_bf16 v[64:79], v[28:31], a[16:19], v[64:79]
    ds_read_b64_tr_b16 v[16:17], v5 offset:38912
    ds_read_b64_tr_b16 v[18:19], v5 offset:39168
    s_waitcnt lgkmcnt(10)
    v_mfma_f32_32x32x16_bf16 v[80:95], a[16:19], v[32:35], v[80:95]
    ds_read_b64_tr_b16 v[20:21], v6 offset:6144
    ds_read_b64_tr_b16 v[22:23], v6 offset:6400
    s_and_b32 s39, s39, 32767
    s_add_u32 s32, s38, s39
    s_add_u32 s39, s39, 4096
    buffer_load_dwordx4 a[48:51], v2, s[8:11], s32 offen offset:0 sc1
    s_waitcnt vmcnt(7) lgkmcnt(10)
    v_mfma_f32_32x32x16_bf16 v[48:63], v[36:39], a[20:23], v[48:63]
    ds_read_b64_tr_b16 v[24:25], v5 offset:7168
    ds_read_b64_tr_b16 v[26:27], v5 offset:7424
    s_waitcnt lgkmcnt(10)
    v_mfma_f32_32x32x16_bf16 v[64:79], v[40:43], a[20:23], v[64:79]
    ds_read_b64_tr_b16 v[28:29], v5 offset:39936
    ds_read_b64_tr_b16 v[30:31], v5 offset:40192
    s_waitcnt lgkmcnt(10)
    v_mfma_f32_32x32x16_bf16 v[80:95], a[20:23], v[44:47], v[80:95]
    ds_read_b64_tr_b16 v[32:33], v6 offset:7168
    ds_read_b64_tr_b16 v[34:35], v6 offset:7424
    buffer_load_dwordx4 a[52:55], v2, s[8:11], s32 offen offset:1024 sc1
    s_waitcnt vmcnt(7) lgkmcnt(10)
    v_mfma_f32_32x32x16_bf16 v[48:63], v[12:15], a[24:27], v[48:63]
    ds_read_b64_tr_b16 v[36:37], v5 offset:8192
    ds_read_b64_tr_b16 v[38:39], v5 offset:8448
    s_waitcnt lgkmcnt(10)
    v_mfma_f32_32x32x16_bf16 v[64:79], v[16:19], a[24:27], v[64:79]
    ds_read_b64_tr_b16 v[40:41], v5 offset:40960
    ds_read_b64_tr_b16 v[42:43], v5 offset:41216
    s_waitcnt lgkmcnt(10)
    v_mfma_f32_32x32x16_bf16 v[80:95], a[24:27], v[20:23], v[80:95]
    ds_read_b64_tr_b16 v[44:45], v6 offset:8192
    ds_read_b64_tr_b16 v[46:47], v6 offset:8448
    buffer_load_dwordx4 a[56:59], v2, s[8:11], s32 offen offset:2048 sc1
    s_waitcnt vmcnt(7) lgkmcnt(10)
    v_mfma_f32_32x32x16_bf16 v[48:63], v[24:27], a[28:31], v[48:63]
    ds_read_b64_tr_b16 v[12:13], v5 offset:9216
    ds_read_b64_tr_b16 v[14:15], v5 offset:9472
    s_waitcnt lgkmcnt(10)
    v_mfma_f32_32x32x16_bf16 v[64:79], v[28:31], a[28:31], v[64:79]
    ds_read_b64_tr_b16 v[16:17], v5 offset:41984
    ds_read_b64_tr_b16 v[18:19], v5 offset:42240
    s_waitcnt lgkmcnt(10)
    v_mfma_f32_32x32x16_bf16 v[80:95], a[28:31], v[32:35], v[80:95]
    ds_read_b64_tr_b16 v[20:21], v6 offset:9216
    ds_read_b64_tr_b16 v[22:23], v6 offset:9472
    buffer_load_dwordx4 a[60:63], v2, s[8:11], s32 offen offset:3072 sc1
    s_waitcnt vmcnt(7) lgkmcnt(10)
    v_mfma_f32_32x32x16_bf16 v[48:63], v[36:39], a[32:35], v[48:63]
    ds_read_b64_tr_b16 v[24:25], v5 offset:10240
    ds_read_b64_tr_b16 v[26:27], v5 offset:10496
    s_waitcnt lgkmcnt(10)
    v_mfma_f32_32x32x16_bf16 v[64:79], v[40:43], a[32:35], v[64:79]
    ds_read_b64_tr_b16 v[28:29], v5 offset:43008
    ds_read_b64_tr_b16 v[30:31], v5 offset:43264
    s_waitcnt lgkmcnt(10)
    v_mfma_f32_32x32x16_bf16 v[80:95], a[32:35], v[44:47], v[80:95]
    ds_read_b64_tr_b16 v[32:33], v6 offset:10240
    ds_read_b64_tr_b16 v[34:35], v6 offset:10496
    s_and_b32 s39, s39, 32767
    s_add_u32 s32, s38, s39
    s_add_u32 s39, s39, 4096
    buffer_load_dwordx4 a[64:67], v2, s[8:11], s32 offen offset:0 sc1
    s_waitcnt vmcnt(7) lgkmcnt(10)
    v_mfma_f32_32x32x16_bf16 v[48:63], v[12:15], a[36:39], v[48:63]
    ds_read_b64_tr_b16 v[36:37], v5 offset:11264
    ds_read_b64_tr_b16 v[38:39], v5 offset:11520
    s_waitcnt lgkmcnt(10)
    v_mfma_f32_32x32x16_bf16 v[64:79], v[16:19], a[36:39], v[64:79]
    ds_read_b64_tr_b16 v[40:41], v5 offset:44032
    ds_read_b64_tr_b16 v[42:43], v5 offset:44288
    s_waitcnt lgkmcnt(10)
    v_mfma_f32_32x32x16_bf16 v[80:95], a[36:39], v[20:23], v[80:95]
    ds_read_b64_tr_b16 v[44:45], v6 offset:11264
    ds_read_b64_tr_b16 v[46:47], v6 offset:11520
    buffer_load_dwordx4 a[68:71], v2, s[8:11], s32 offen offset:1024 sc1
    s_waitcnt vmcnt(7) lgkmcnt(10)
    v_mfma_f32_32x32x16_bf16 v[48:63], v[24:27], a[40:43], v[48:63]
    ds_read_b64_tr_b16 v[12:13], v5 offset:12288
    ds_read_b64_tr_b16 v[14:15], v5 offset:12544
    s_waitcnt lgkmcnt(10)
    v_mfma_f32_32x32x16_bf16 v[64:79], v[28:31], a[40:43], v[64:79]
    ds_read_b64_tr_b16 v[16:17], v5 offset:45056
    ds_read_b64_tr_b16 v[18:19], v5 offset:45312
    s_waitcnt lgkmcnt(10)
    v_mfma_f32_32x32x16_bf16 v[80:95], a[40:43], v[32:35], v[80:95]
    ds_read_b64_tr_b16 v[20:21], v6 offset:12288
    ds_read_b64_tr_b16 v[22:23], v6 offset:12544
    buffer_load_dwordx4 a[72:75], v2, s[8:11], s32 offen offset:2048 sc1
    s_waitcnt vmcnt(7) lgkmcnt(10)
    v_mfma_f32_32x32x16_bf16 v[48:63], v[36:39], a[44:47], v[48:63]
    ds_read_b64_tr_b16 v[24:25], v5 offset:13312
    ds_read_b64_tr_b16 v[26:27], v5 offset:13568
    s_waitcnt lgkmcnt(10)
    v_mfma_f32_32x32x16_bf16 v[64:79], v[40:43], a[44:47], v[64:79]
    ds_read_b64_tr_b16 v[28:29], v5 offset:46080
    ds_read_b64_tr_b16 v[30:31], v5 offset:46336
    s_waitcnt lgkmcnt(10)
    v_mfma_f32_32x32x16_bf16 v[80:95], a[44:47], v[44:47], v[80:95]
    ds_read_b64_tr_b16 v[32:33], v6 offset:13312
    ds_read_b64_tr_b16 v[34:35], v6 offset:13568
    buffer_load_dwordx4 a[76:79], v2, s[8:11], s32 offen offset:3072 sc1
    s_waitcnt vmcnt(7) lgkmcnt(10)
    v_mfma_f32_32x32x16_bf16 v[48:63], v[12:15], a[48:51], v[48:63]
    ds_read_b64_tr_b16 v[36:37], v5 offset:14336
    ds_read_b64_tr_b16 v[38:39], v5 offset:14592
    s_waitcnt lgkmcnt(10)
    v_mfma_f32_32x32x16_bf16 v[64:79], v[16:19], a[48:51], v[64:79]
    ds_read_b64_tr_b16 v[40:41], v5 offset:47104
    ds_read_b64_tr_b16 v[42:43], v5 offset:47360
    s_waitcnt lgkmcnt(10)
    v_mfma_f32_32x32x16_bf16 v[80:95], a[48:51], v[20:23], v[80:95]
    ds_read_b64_tr_b16 v[44:45], v6 offset:14336
    ds_read_b64_tr_b16 v[46:47], v6 offset:14592
    s_and_b32 s39, s39, 32767
    s_add_u32 s32, s38, s39
    s_add_u32 s39, s39, 4096
    buffer_load_dwordx4 a[80:83], v2, s[8:11], s32 offen offset:0 sc1
    s_waitcnt vmcnt(7) lgkmcnt(10)
    v_mfma_f32_32x32x16_bf16 v[48:63], v[24:27], a[52:55], v[48:63]
    ds_read_b64_tr_b16 v[12:13], v5 offset:15360
    ds_read_b64_tr_b16 v[14:15], v5 offset:15616
    s_waitcnt lgkmcnt(10)
    v_mfma_f32_32x32x16_bf16 v[64:79], v[28:31], a[52:55], v[64:79]
    ds_read_b64_tr_b16 v[16:17], v5 offset:48128
    ds_read_b64_tr_b16 v[18:19], v5 offset:48384
    s_waitcnt lgkmcnt(10)
    v_mfma_f32_32x32x16_bf16 v[80:95], a[52:55], v[32:35], v[80:95]
    ds_read_b64_tr_b16 v[20:21], v6 offset:15360
    ds_read_b64_tr_b16 v[22:23], v6 offset:15616
    buffer_load_dwordx4 a[84:87], v2, s[8:11], s32 offen offset:1024 sc1
    s_waitcnt vmcnt(7) lgkmcnt(10)
    v_mfma_f32_32x32x16_bf16 v[48:63], v[36:39], a[56:59], v[48:63]
    ds_read_b64_tr_b16 v[24:25], v5 offset:16384
    ds_read_b64_tr_b16 v[26:27], v5 offset:16640
    s_waitcnt lgkmcnt(10)
    v_mfma_f32_32x32x16_bf16 v[64:79], v[40:43], a[56:59], v[64:79]
    ds_read_b64_tr_b16 v[28:29], v5 offset:49152
    ds_read_b64_tr_b16 v[30:31], v5 offset:49408
    s_waitcnt lgkmcnt(10)
    v_mfma_f32_32x32x16_bf16 v[80:95], a[56:59], v[44:47], v[80:95]
    ds_read_b64_tr_b16 v[32:33], v6 offset:16384
    ds_read_b64_tr_b16 v[34:35], v6 offset:16640
    buffer_load_dwordx4 a[88:91], v2, s[8:11], s32 offen offset:2048 sc1
    s_waitcnt vmcnt(7) lgkmcnt(10)
    v_mfma_f32_32x32x16_bf16 v[48:63], v[12:15], a[60:63], v[48:63]
    ds_read_b64_tr_b16 v[36:37], v5 offset:17408
    ds_read_b64_tr_b16 v[38:39], v5 offset:17664
    s_waitcnt lgkmcnt(10)
    v_mfma_f32_32x32x16_bf16 v[64:79], v[16:19], a[60:63], v[64:79]
    ds_read_b64_tr_b16 v[40:41], v5 offset:50176
    ds_read_b64_tr_b16 v[42:43], v5 offset:50432
    s_waitcnt lgkmcnt(10)
    v_mfma_f32_32x32x16_bf16 v[80:95], a[60:63], v[20:23], v[80:95]
    ds_read_b64_tr_b16 v[44:45], v6 offset:17408
    ds_read_b64_tr_b16 v[46:47], v6 offset:17664
    buffer_load_dwordx4 a[92:95], v2, s[8:11], s32 offen offset:3072 sc1
    s_waitcnt vmcnt(7) lgkmcnt(10)
    v_mfma_f32_32x32x16_bf16 v[48:63], v[24:27], a[64:67], v[48:63]
    ds_read_b64_tr_b16 v[12:13], v5 offset:18432
    ds_read_b64_tr_b16 v[14:15], v5 offset:18688
    s_waitcnt lgkmcnt(10)
    v_mfma_f32_32x32x16_bf16 v[64:79], v[28:31], a[64:67], v[64:79]
    ds_read_b64_tr_b16 v[16:17], v5 offset:51200
    ds_read_b64_tr_b16 v[18:19], v5 offset:51456
    s_waitcnt lgkmcnt(10)
    v_mfma_f32_32x32x16_bf16 v[80:95], a[64:67], v[32:35], v[80:95]
    ds_read_b64_tr_b16 v[20:21], v6 offset:18432
    ds_read_b64_tr_b16 v[22:23], v6 offset:18688
    s_and_b32 s39, s39, 32767
    s_add_u32 s32, s38, s39
    s_add_u32 s39, s39, 4096
    buffer_load_dwordx4 a[96:99], v2, s[8:11], s32 offen offset:0 sc1
    s_waitcnt vmcnt(7) lgkmcnt(10)
    v_mfma_f32_32x32x16_bf16 v[48:63], v[36:39], a[68:71], v[48:63]
    ds_read_b64_tr_b16 v[24:25], v5 offset:19456
    ds_read_b64_tr_b16 v[26:27], v5 offset:19712
    s_waitcnt lgkmcnt(10)
    v_mfma_f32_32x32x16_bf16 v[64:79], v[40:43], a[68:71], v[64:79]
    ds_read_b64_tr_b16 v[28:29], v5 offset:52224
    ds_read_b64_tr_b16 v[30:31], v5 offset:52480
    s_waitcnt lgkmcnt(10)
    v_mfma_f32_32x32x16_bf16 v[80:95], a[68:71], v[44:47], v[80:95]
    ds_read_b64_tr_b16 v[32:33], v6 offset:19456
    ds_read_b64_tr_b16 v[34:35], v6 offset:19712
    buffer_load_dwordx4 a[100:103], v2, s[8:11], s32 offen offset:1024 sc1
    s_waitcnt vmcnt(7) lgkmcnt(10)
    v_mfma_f32_32x32x16_bf16 v[48:63], v[12:15], a[72:75], v[48:63]
    ds_read_b64_tr_b16 v[36:37], v5 offset:20480
    ds_read_b64_tr_b16 v[38:39], v5 offset:20736
    s_waitcnt lgkmcnt(10)
    v_mfma_f32_32x32x16_bf16 v[64:79], v[16:19], a[72:75], v[64:79]
    ds_read_b64_tr_b16 v[40:41], v5 offset:53248
    ds_read_b64_tr_b16 v[42:43], v5 offset:53504
    s_waitcnt lgkmcnt(10)
    v_mfma_f32_32x32x16_bf16 v[80:95], a[72:75], v[20:23], v[80:95]
    ds_read_b64_tr_b16 v[44:45], v6 offset:20480
    ds_read_b64_tr_b16 v[46:47], v6 offset:20736
    buffer_load_dwordx4 a[104:107], v2, s[8:11], s32 offen offset:2048 sc1
    s_waitcnt vmcnt(7) lgkmcnt(10)
    v_mfma_f32_32x32x16_bf16 v[48:63], v[24:27], a[76:79], v[48:63]
    ds_read_b64_tr_b16 v[12:13], v5 offset:21504
    ds_read_b64_tr_b16 v[14:15], v5 offset:21760
    s_waitcnt lgkmcnt(10)
    v_mfma_f32_32x32x16_bf16 v[64:79], v[28:31], a[76:79], v[64:79]
    ds_read_b64_tr_b16 v[16:17], v5 offset:54272
    ds_read_b64_tr_b16 v[18:19], v5 offset:54528
    s_waitcnt lgkmcnt(10)
    v_mfma_f32_32x32x16_bf16 v[80:95], a[76:79], v[32:35], v[80:95]
    ds_read_b64_tr_b16 v[20:21], v6 offset:21504
    ds_read_b64_tr_b16 v[22:23], v6 offset:21760
    buffer_load_dwordx4 a[108:111], v2, s[8:11], s32 offen offset:3072 sc1
    s_waitcnt vmcnt(7) lgkmcnt(10)
    v_mfma_f32_32x32x16_bf16 v[48:63], v[36:39], a[80:83], v[48:63]
    ds_read_b64_tr_b16 v[24:25], v5 offset:22528
    ds_read_b64_tr_b16 v[26:27], v5 offset:22784
    s_waitcnt lgkmcnt(10)
    v_mfma_f32_32x32x16_bf16 v[64:79], v[40:43], a[80:83], v[64:79]
    ds_read_b64_tr_b16 v[28:29], v5 offset:55296
    ds_read_b64_tr_b16 v[30:31], v5 offset:55552
    s_waitcnt lgkmcnt(10)
    v_mfma_f32_32x32x16_bf16 v[80:95], a[80:83], v[44:47], v[80:95]
    ds_read_b64_tr_b16 v[32:33], v6 offset:22528
    ds_read_b64_tr_b16 v[34:35], v6 offset:22784
    s_and_b32 s39, s39, 32767
    s_add_u32 s32, s38, s39
    s_add_u32 s39, s39, 4096
    buffer_load_dwordx4 a[112:115], v2, s[8:11], s32 offen offset:0 sc1
    s_waitcnt vmcnt(7) lgkmcnt(10)
    v_mfma_f32_32x32x16_bf16 v[48:63], v[12:15], a[84:87], v[48:63]
    ds_read_b64_tr_b16 v[36:37], v5 offset:23552
    ds_read_b64_tr_b16 v[38:39], v5 offset:23808
    s_waitcnt lgkmcnt(10)
    v_mfma_f32_32x32x16_bf16 v[64:79], v[16:19], a[84:87], v[64:79]
    ds_read_b64_tr_b16 v[40:41], v5 offset:56320
    ds_read_b64_tr_b16 v[42:43], v5 offset:56576
    s_waitcnt lgkmcnt(10)
    v_mfma_f32_32x32x16_bf16 v[80:95], a[84:87], v[20:23], v[80:95]
    ds_read_b64_tr_b16 v[44:45], v6 offset:23552
    ds_read_b64_tr_b16 v[46:47], v6 offset:23808
    buffer_load_dwordx4 a[116:119], v2, s[8:11], s32 offen offset:1024 sc1
    s_waitcnt vmcnt(7) lgkmcnt(10)
    v_mfma_f32_32x32x16_bf16 v[48:63], v[24:27], a[88:91], v[48:63]
    ds_read_b64_tr_b16 v[12:13], v5 offset:24576
    ds_read_b64_tr_b16 v[14:15], v5 offset:24832
    s_waitcnt lgkmcnt(10)
    v_mfma_f32_32x32x16_bf16 v[64:79], v[28:31], a[88:91], v[64:79]
    ds_read_b64_tr_b16 v[16:17], v5 offset:57344
    ds_read_b64_tr_b16 v[18:19], v5 offset:57600
    s_waitcnt lgkmcnt(10)
    v_mfma_f32_32x32x16_bf16 v[80:95], a[88:91], v[32:35], v[80:95]
    ds_read_b64_tr_b16 v[20:21], v6 offset:24576
    ds_read_b64_tr_b16 v[22:23], v6 offset:24832
    buffer_load_dwordx4 a[120:123], v2, s[8:11], s32 offen offset:2048 sc1
    s_waitcnt vmcnt(7) lgkmcnt(10)
    v_mfma_f32_32x32x16_bf16 v[48:63], v[36:39], a[92:95], v[48:63]
    ds_read_b64_tr_b16 v[24:25], v5 offset:25600
    ds_read_b64_tr_b16 v[26:27], v5 offset:25856
    s_waitcnt lgkmcnt(10)
    v_mfma_f32_32x32x16_bf16 v[64:79], v[40:43], a[92:95], v[64:79]
    ds_read_b64_tr_b16 v[28:29], v5 offset:58368
    ds_read_b64_tr_b16 v[30:31], v5 offset:58624
    s_waitcnt lgkmcnt(10)
    v_mfma_f32_32x32x16_bf16 v[80:95], a[92:95], v[44:47], v[80:95]
    ds_read_b64_tr_b16 v[32:33], v6 offset:25600
    ds_read_b64_tr_b16 v[34:35], v6 offset:25856
    buffer_load_dwordx4 a[124:127], v2, s[8:11], s32 offen offset:3072 sc1
    s_waitcnt vmcnt(7) lgkmcnt(10)
    v_mfma_f32_32x32x16_bf16 v[48:63], v[12:15], a[96:99], v[48:63]
    ds_read_b64_tr_b16 v[36:37], v5 offset:26624
    ds_read_b64_tr_b16 v[38:39], v5 offset:26880
    s_waitcnt lgkmcnt(10)
    v_mfma_f32_32x32x16_bf16 v[64:79], v[16:19], a[96:99], v[64:79]
    ds_read_b64_tr_b16 v[40:41], v5 offset:59392
    ds_read_b64_tr_b16 v[42:43], v5 offset:59648
    s_waitcnt lgkmcnt(10)
    v_mfma_f32_32x32x16_bf16 v[80:95], a[96:99], v[20:23], v[80:95]
    ds_read_b64_tr_b16 v[44:45], v6 offset:26624
    ds_read_b64_tr_b16 v[46:47], v6 offset:26880
    s_waitcnt vmcnt(6) lgkmcnt(10)
    v_mfma_f32_32x32x16_bf16 v[48:63], v[24:27], a[100:103], v[48:63]
    ds_read_b64_tr_b16 v[12:13], v5 offset:27648
    ds_read_b64_tr_b16 v[14:15], v5 offset:27904
    s_waitcnt lgkmcnt(10)
    v_mfma_f32_32x32x16_bf16 v[64:79], v[28:31], a[100:103], v[64:79]
    ds_read_b64_tr_b16 v[16:17], v5 offset:60416
    ds_read_b64_tr_b16 v[18:19], v5 offset:60672
    s_waitcnt lgkmcnt(10)
    v_mfma_f32_32x32x16_bf16 v[80:95], a[100:103], v[32:35], v[80:95]
    ds_read_b64_tr_b16 v[20:21], v6 offset:27648
    ds_read_b64_tr_b16 v[22:23], v6 offset:27904
    s_waitcnt vmcnt(5) lgkmcnt(10)
    v_mfma_f32_32x32x16_bf16 v[48:63], v[36:39], a[104:107], v[48:63]
    ds_read_b64_tr_b16 v[24:25], v5 offset:28672
    ds_read_b64_tr_b16 v[26:27], v5 offset:28928
    s_waitcnt lgkmcnt(10)
    v_mfma_f32_32x32x16_bf16 v[64:79], v[40:43], a[104:107], v[64:79]
    ds_read_b64_tr_b16 v[28:29], v5 offset:61440
    ds_read_b64_tr_b16 v[30:31], v5 offset:61696
    s_waitcnt lgkmcnt(10)
    v_mfma_f32_32x32x16_bf16 v[80:95], a[104:107], v[44:47], v[80:95]
    ds_read_b64_tr_b16 v[32:33], v6 offset:28672
    ds_read_b64_tr_b16 v[34:35], v6 offset:28928
    s_waitcnt vmcnt(4) lgkmcnt(10)
    v_mfma_f32_32x32x16_bf16 v[48:63], v[12:15], a[108:111], v[48:63]
    ds_read_b64_tr_b16 v[36:37], v5 offset:29696
    ds_read_b64_tr_b16 v[38:39], v5 offset:29952
    s_waitcnt lgkmcnt(10)
    v_mfma_f32_32x32x16_bf16 v[64:79], v[16:19], a[108:111], v[64:79]
    ds_read_b64_tr_b16 v[40:41], v5 offset:62464
    ds_read_b64_tr_b16 v[42:43], v5 offset:62720
    s_waitcnt lgkmcnt(10)
    v_mfma_f32_32x32x16_bf16 v[80:95], a[108:111], v[20:23], v[80:95]
    ds_read_b64_tr_b16 v[44:45], v6 offset:29696
    ds_read_b64_tr_b16 v[46:47], v6 offset:29952
    s_waitcnt vmcnt(3) lgkmcnt(10)
    v_mfma_f32_32x32x16_bf16 v[48:63], v[24:27], a[112:115], v[48:63]
    ds_read_b64_tr_b16 v[12:13], v5 offset:30720
    ds_read_b64_tr_b16 v[14:15], v5 offset:30976
    s_waitcnt lgkmcnt(10)
    v_mfma_f32_32x32x16_bf16 v[64:79], v[28:31], a[112:115], v[64:79]
    ds_read_b64_tr_b16 v[16:17], v5 offset:63488
    ds_read_b64_tr_b16 v[18:19], v5 offset:63744
    s_waitcnt lgkmcnt(10)
    v_mfma_f32_32x32x16_bf16 v[80:95], a[112:115], v[32:35], v[80:95]
    ds_read_b64_tr_b16 v[20:21], v6 offset:30720
    ds_read_b64_tr_b16 v[22:23], v6 offset:30976
    s_waitcnt vmcnt(2) lgkmcnt(10)
    v_mfma_f32_32x32x16_bf16 v[48:63], v[36:39], a[116:119], v[48:63]
    ds_read_b64_tr_b16 v[24:25], v5 offset:31744
    ds_read_b64_tr_b16 v[26:27], v5 offset:32000
    s_waitcnt lgkmcnt(10)
    v_mfma_f32_32x32x16_bf16 v[64:79], v[40:43], a[116:119], v[64:79]
    ds_read_b64_tr_b16 v[28:29], v5 offset:64512
    ds_read_b64_tr_b16 v[30:31], v5 offset:64768
    s_waitcnt lgkmcnt(10)
    v_mfma_f32_32x32x16_bf16 v[80:95], a[116:119], v[44:47], v[80:95]
    ds_read_b64_tr_b16 v[32:33], v6 offset:31744
    ds_read_b64_tr_b16 v[34:35], v6 offset:32000
    s_waitcnt vmcnt(1) lgkmcnt(10)
    v_mfma_f32_32x32x16_bf16 v[48:63], v[12:15], a[120:123], v[48:63]
    s_waitcnt lgkmcnt(8)
    v_mfma_f32_32x32x16_bf16 v[64:79], v[16:19], a[120:123], v[64:79]
    s_waitcnt lgkmcnt(6)
    v_mfma_f32_32x32x16_bf16 v[80:95], a[120:123], v[20:23], v[80:95]
    s_waitcnt vmcnt(0) lgkmcnt(4)
    v_mfma_f32_32x32x16_bf16 v[48:63], v[24:27], a[124:127], v[48:63]
    s_waitcnt lgkmcnt(2)
    v_mfma_f32_32x32x16_bf16 v[64:79], v[28:31], a[124:127], v[64:79]
    s_waitcnt lgkmcnt(0)
    v_mfma_f32_32x32x16_bf16 v[80:95], a[124:127], v[32:35], v[80:95]
    s_nop 9
    v_cvt_pk_bf16_f32 v20, v64, v65
    v_cvt_pk_bf16_f32 v21, v66, v67
    v_cvt_pk_bf16_f32 v22, v68, v69
    v_cvt_pk_bf16_f32 v23, v70, v71
    buffer_store_dwordx4 v[20:23], v7, s[8:11], s80 offen offset:0 sc1
    v_cvt_pk_bf16_f32 v24, v72, v73
    v_cvt_pk_bf16_f32 v25, v74, v75
    v_cvt_pk_bf16_f32 v26, v76, v77
    v_cvt_pk_bf16_f32 v27, v78, v79
    buffer_store_dwordx4 v[24:27], v7, s[8:11], s81 offen offset:0 sc1
    v_cvt_pk_bf16_f32 v28, v80, v81
    v_cvt_pk_bf16_f32 v29, v82, v83
    v_cvt_pk_bf16_f32 v30, v84, v85
    v_cvt_pk_bf16_f32 v31, v86, v87
    buffer_store_dwordx4 v[28:31], v8, s[8:11], s84 offen offset:0 sc1
    v_cvt_pk_bf16_f32 v32, v88, v89
    v_cvt_pk_bf16_f32 v33, v90, v91
    v_cvt_pk_bf16_f32 v34, v92, v93
    v_cvt_pk_bf16_f32 v35, v94, v95
    buffer_store_dwordx4 v[32:35], v8, s[8:11], s84 offen offset:512 sc1
    v_mul_f32 v48, s85, v48
    v_mul_f32 v49, s85, v49
    v_mul_f32 v50, s85, v50
    v_mul_f32 v51, s85, v51
    v_mul_f32 v52, s85, v52
    v_mul_f32 v53, s85, v53
    v_mul_f32 v54, s85, v54
    v_mul_f32 v55, s85, v55
    v_mul_f32 v56, s85, v56
    v_mul_f32 v57, s85, v57
    v_mul_f32 v58, s85, v58
    v_mul_f32 v59, s85, v59
    v_mul_f32 v60, s85, v60
    v_mul_f32 v61, s85, v61
    v_mul_f32 v62, s85, v62
    v_mul_f32 v63, s85, v63
    v_cvt_pk_bf16_f32 v12, v48, v49
    v_cvt_pk_bf16_f32 v13, v50, v51
    v_cvt_pk_bf16_f32 v14, v52, v53
    v_cvt_pk_bf16_f32 v15, v54, v55
    buffer_store_dwordx4 v[12:15], v2, s[8:11], s78 offen offset:0 sc1
    v_cvt_pk_bf16_f32 v16, v56, v57
    v_cvt_pk_bf16_f32 v17, v58, v59
    v_cvt_pk_bf16_f32 v18, v60, v61
    v_cvt_pk_bf16_f32 v19, v62, v63
    buffer_store_dwordx4 v[16:19], v2, s[8:11], s79 offen offset:0 sc1
    s_waitcnt vmcnt(0)
    v_mov_b32 v11, 163792
    v_mov_b32 v10, 1
    s_mov_b64 exec, 1
    ds_add_rtn_u32 v10, v11, v10
    s_mov_b64 exec, -1
    s_waitcnt lgkmcnt(0)
    v_readfirstlane_b32 s32, v10
    s_cmp_lg_u32 s32, 3
    s_cbranch_scc1 L_lo_nofq
    v_mov_b32 v10, s4
    s_mov_b64 exec, 1
    buffer_store_dword v10, v3, s[8:11], s67 offen sc1
    s_mov_b64 exec, -1
L_lo_nofq:
L_p1_end:
    s_mov_b32 s76, s56
    s_mov_b32 s77, s57
    s_and_b32 s36, s3, 3
    s_lshr_b32 s37, s3, 2
    s_lshl_b32 s32, s77, 3
    s_lshl_b32 s33, s36, 1
    s_add_u32 s32, s32, s33
    s_add_u32 s58, s32, s37
    s_xor_b32 s33, s58, 1
    s_lshl_b32 s34, s76, 16
    s_add_u32 s35, s34, 3145728
    s_lshl_b32 s32, s58, 10
    s_add_u32 s42, s35, s32
    s_lshl_b32 s33, s33, 10
    s_add_u32 s43, s35, s33
    s_and_b32 s32, s3, 1
    s_mul_i32 s38, s32, 2097152
    s_add_u32 s38, s38, s34
    s_add_u32 s38, s38, 5242880
    s_bfe_u32 s33, s3, 0x10001
    s_lshl_b32 s34, s33, 5
    s_add_u32 s34, s34, s37
    s_lshl_b32 s35, s34, 10
    s_add_u32 s38, s38, s35
    s_mul_i32 s44, s32, 32
    s_add_u32 s44, s44, 1024
    s_mul_i32 s39, s34, s44
    s_mul_i32 s32, s32, 65536
    s_add_u32 s39, s39, s32
    s_lshl_b32 s44, s44, 1
    s_sub_u32 s45, s44, 2048
    s_lshl_b32 s48, s44, 1
    s_lshl_b32 s32, s56, 1
    s_and_b32 s33, s3, 1
    s_add_u32 s59, s32, s33
    s_lshl_b32 s32, s37, 1
    s_add_u32 s61, s32, s33
    s_lshl_b32 s32, s57, 2
    s_and_b32 s33, s3, 2
    s_add_u32 s32, s32, s33
    s_add_u32 s60, s32, s37
    s_mul_i32 s32, s57, 7
    s_add_u32 s63, s32, s3
    s_and_b32 s32, s56, 3
    s_lshl_b32 s32, s32, 1
    s_add_u32 s32, s32, s57
    s_cmp_ge_u32 s32, 7
    s_cselect_b32 s33, 7, 0
    s_sub_u32 s32, s32, s33
    s_lshl_b32 s62, s32, 12
    s_lshl_b32 s32, s37, 15
    v_add_u32 v4, s32, v2
    s_mul_i32 s32, s37, 33792
    s_add_u32 s32, s32, 65536
    v_lshrrev_b32 v10, 5, v1
    v_lshlrev_b32 v7, 4, v10
    v_lshlrev_b32 v5, 8, v10
    v_and_b32 v10, 15, v1
    v_lshl_add_u32 v5, v10, 4, v5
    v_add_u32 v6, 512, v5
    v_and_b32 v10, 27, v1
    v_cmp_eq_u32 vcc, 16, v10
    v_mov_b32 v11, 1040
    v_mov_b32 v8, 1024
    v_cndmask_b32 v11, v11, v8, vcc
    v_and_b32 v10, 16, v1
    v_cmp_ne_u32 vcc, 0, v10
    v_mov_b32 v9, 0xdddddddd
    v_mul_u32_u24 v124, 1056, v1
    v_cndmask_b32 v5, v5, v11, vcc
    v_cndmask_b32 v6, v6, v11, vcc
    v_add_u32 v5, s32, v5
    v_add_u32 v6, s32, v6
    v_add_u32 v124, 66560, v124
    v_mov_b32 v24, 0x3f803f80
    v_mov_b32 v28, 0
    v_mov_b32 v25, 0x3f803f80
    v_mov_b32 v29, 0
    v_mov_b32 v26, 0x3f803f80
    v_mov_b32 v30, 0
    v_mov_b32 v27, 0x3f803f80
    v_mov_b32 v31, 0
    v_mov_b64 v[64:65], 0
    v_mov_b64 v[80:81], 0
    v_mov_b64 v[66:67], 0
    v_mov_b64 v[82:83], 0
    v_mov_b64 v[68:69], 0
    v_mov_b64 v[84:85], 0
    v_mov_b64 v[70:71], 0
    v_mov_b64 v[86:87], 0
    v_mov_b64 v[72:73], 0
    v_mov_b64 v[88:89], 0
    v_mov_b64 v[74:75], 0
    v_mov_b64 v[90:91], 0
    v_mov_b64 v[76:77], 0
    v_mov_b64 v[92:93], 0
    v_mov_b64 v[78:79], 0
    v_mov_b64 v[94:95], 0
    v_mov_b64 v[56:57], 0
    v_mov_b64 v[58:59], 0
    v_mov_b64 v[60:61], 0
    v_mov_b64 v[62:63], 0
    s_mov_b32 s23, 0x20000
    s_mov_b32 s27, 0x20000
    s_lshr_b32 s34, s3, 1
    s_and_b32 s35, s3, 1
    s_cmp_lt_u32 s2, 224
    s_cbranch_scc0 L_fj_b
    s_mov_b32 s20, s72
    s_mov_b32 s21, s73
    s_mov_b32 s22, 1835008
    s_mov_b32 s24, s74
    s_mov_b32 s25, s75
    s_mov_b32 s26, 1835008
    s_lshr_b32 s32, s2, 3
    s_and_b32 s33, s2, 7
    s_lshl_b32 s90, s33, 3
    s_add_u32 s90, s90, s3
    s_mul_i32 s90, s90, 28672
    s_lshl_b32 s88, s32, 7
    s_add_u32 s90, s90, s88
    s_lshl_b32 s88, s32, 1
    s_add_u32 s88, s88, s35
    s_lshl_b32 s89, s33, 2
    s_add_u32 s89, s89, s34
    s_lshl_b32 s32, s88, 5
    s_add_u32 s32, s32, s89
    s_lshl_b32 s91, s32, 10
    s_add_u32 s91, s91, 14155776
    s_mul_i32 s32, s2, 2341
    s_lshr_b32 s32, s32, 16
    s_mul_i32 s33, s32, 28
    s_sub_u32 s33, s2, s33
    s_lshl_b32 s92, s33, 3
    s_add_u32 s92, s92, s3
    s_lshl_b32 s92, s92, 13
    s_lshl_b32 s93, s32, 7
    s_add_u32 s92, s92, s93
    s_lshl_b32 s32, s32, 1
    s_add_u32 s32, s32, s35
    s_mul_i32 s32, s32, 112
    s_lshl_b32 s33, s33, 2
    s_add_u32 s32, s32, s33
    s_add_u32 s32, s32, s34
    s_lshl_b32 s93, s32, 10
    s_add_u32 s93, s93, 15990784
    s_movk_i32 s32, 3584
    s_branch L_fj_c
L_fj_b:
    s_mov_b32 s20, s68
    s_mov_b32 s21, s69
    s_mov_b32 s22, 524288
    s_mov_b32 s24, s68
    s_mov_b32 s25, s69
    s_mov_b32 s26, 524288
    s_sub_u32 s32, s2, 224
    s_and_b32 s33, s32, 3
    s_lshr_b32 s32, s32, 2
    s_lshl_b32 s90, s33, 4
    s_add_u32 s90, s90, s3
    s_lshl_b32 s90, s90, 13
    s_lshl_b32 s92, s32, 7
    s_add_u32 s90, s90, s92
    s_add_u32 s92, s90, 65536
    s_lshl_b32 s32, s32, 1
    s_add_u32 s32, s32, s35
    s_lshl_b32 s32, s32, 2
    s_add_u32 s32, s32, s33
    s_lshl_b32 s32, s32, 3
    s_add_u32 s32, s32, s34
    s_lshl_b32 s91, s32, 10
    s_add_u32 s91, s91, 13631488
    s_add_u32 s93, s91, 4096
    s_mov_b32 s88, 0
    s_mov_b32 s89, 0
    s_movk_i32 s32, 1024
L_fj_c:
    v_lshrrev_b32 v10, 3, v1
    v_and_b32 v11, 7, v1
    v_lshlrev_b32 v11, 4, v11
    v_mad_u32_u24 v116, v10, s32, v11
    v_lshl_add_u32 v120, v10, 10, v11
    s_lshl_b32 s94, s89, 6
    s_add_u32 s94, s94, 22528
    v_and_b32 v10, 7, v1
    v_bfe_u32 v11, v1, 3, 1
    v_lshlrev_b32 v11, 11, v11
    v_lshl_add_u32 v114, v10, 3, v11
    v_mov_b32 v11, 1073741824
    v_cmp_gt_u32 vcc, 16, v1
    s_lshl_b32 s33, s3, 8
    v_mov_b32 v0, 0
    v_cndmask_b32 v114, v11, v114, vcc
    s_add_u32 s33, s33, 155648
    v_add_u32 v115, s33, v3
    v_lshrrev_b32 v10, 1, v7
    v_add_u32 v113, s33, v10
    s_lshl_b32 s95, s3, 10
    s_add_u32 s95, s95, 133120
    s_lshl_b32 s32, s34, 11
    s_lshl_b32 s33, s35, 6
    s_add_u32 s32, s32, s33
    s_add_u32 s32, s32, 133120
    v_lshl_add_u32 v119, v7, 5, s32
    v_bfe_u32 v10, v1, 2, 2
    v_lshl_add_u32 v119, v10, 7, v119
    v_bfe_u32 v10, v1, 4, 1
    v_lshl_add_u32 v119, v10, 5, v119
    v_and_b32 v10, 3, v1
    v_lshl_add_u32 v119, v10, 3, v119
    s_min_u32 s32, s63, 55
    s_lshr_b32 s32, s32, 1
    s_lshl_b32 s32, s32, 3
    v_add_u32 v8, s32, v1
    s_add_u32 s32, s57, 56
    s_cmp_eq_u32 s3, 7
    s_cselect_b32 s33, s32, s63
    s_lshl_b32 s33, s33, 2
    s_sub_u32 s33, s33, 8
    v_add_u32 v10, s33, v1
    v_cmp_lt_u32 vcc, 7, v1
    s_lshl_b32 s32, s60, 6
    s_add_u32 s32, s32, 20480
    v_cndmask_b32 v8, v8, v10, vcc
    v_lshlrev_b32 v8, 7, v8
    v_add_u32 v8, 229376, v8
    v_and_b32 v10, 7, v1
    v_lshl_add_u32 v10, v10, 3, s32
    v_bfe_u32 v11, v1, 3, 1
    v_mul_u32_u24 v11, 6144, v11
    v_add_u32 v10, v10, v11
    v_cmp_lt_u32 vcc, 15, v1
    s_lshl_b32 s47, s59, 5
    s_add_u32 s47, s47, s60
    s_lshl_b32 s47, s47, 10
    v_cndmask_b32 v8, v8, v10, vcc
    s_getreg_b32 s64, hwreg(HW_REG_XCC_ID, 0, 16)
    s_and_b32 s32, s2, 199
    s_lshl_b32 s32, s32, 7
    s_add_u32 s32, s32, 229376
    v_and_b32 v10, 31, v1
    v_lshl_add_u32 v10, v10, 10, s32
    v_cmp_lt_u32 vcc, 31, v1
    s_mov_b32 s100, 0xffff0fff
    s_mov_b32 s101, 0xff
    v_cndmask_b32 v8, v8, v10, vcc
    v_mov_b32 v11, 1073741824
    v_cndmask_b32 v8, v11, v8, s[100:101]
    v_cmp_eq_u32 vcc, 0, v1
    v_mov_b32 v96, s64
    v_mov_b32 v97, s4
    v_cndmask_b32 v0, v11, v0, vcc
    v_cmp_gt_u32 vcc, 8, v1
    s_lshl_b32 s32, s3, 8
    s_add_u32 s32, s32, 151552
    v_cndmask_b32 v106, v11, v126, vcc
    v_and_b32 v10, 0x7c, v3
    v_add_u32 v98, s32, v10
    s_and_b32 s32, s32, 256
    s_add_u32 s32, s32, 151552
    v_add_u32 v99, s32, v3
    v_and_b32 v10, 31, v1
    v_lshl_add_u32 v107, v10, 10, v7
    s_and_b32 s32, s2, 7
    s_lshl3_add_u32 s32, s88, s32
    s_lshl_b32 s81, s32, 8
    s_add_u32 s81, s81, 262144
    s_cmp_lt_u32 s2, 224
    s_cselect_b32 s81, s81, 1073741824
    s_cselect_b64 s[40:41], -1, 0
    s_cmp_lt_u32 s3, 2
    s_cselect_b32 s81, s81, 1073741824
    s_lshl_b32 s84, s2, 7
    s_add_u32 s84, s84, 229376
    s_cmp_eq_u32 s3, 0
    s_cselect_b32 s84, s84, 1073741824
    s_lshl_b32 s86, s63, 15
    s_add_u32 s86, s86, 14155776
    s_lshl_b32 s87, s56, 13
    s_and_b32 s87, s87, 32767
    s_cmp_eq_u32 s3, 7
    s_cselect_b32 s86, 1073741824, s86
    s_add_u32 s49, s56, s57
    s_lshl_b32 s49, s49, 12
    s_and_b32 s49, s49, 16383
    s_mov_b32 s78, s49
    s_and_b32 s32, s3, 1
    s_bfe_u32 s33, s3, 0x10001
    s_lshl1_add_u32 s99, s32, s33
    s_lshl_b32 s98, s99, 4
    s_add_u32 s98, s98, s37
    s_lshl_b32 s98, s98, 10
    s_lshl_b32 s32, s57, 16
    s_add_u32 s67, s98, s32
    s_add_u32 s67, s67, 13631488
    s_lshl_b32 s85, s63, 11
    s_add_u32 s85, s85, 262144
    s_lshl_b32 s96, s59, 15
    s_lshl_b32 s32, s60, 5
    s_add_u32 s96, s96, s32
    s_and_b32 s32, s56, 3
    s_lshl3_add_u32 s32, s32, s3
    s_mul_i32 s32, s32, 7168
    s_mul_i32 s97, s57, 229376
    s_add_u32 s97, s97, s32
    s_add_u32 s97, s97, 15990784
    s_bitcmp1_b32 s99, 0
    s_mov_b32 s34, 0
    s_mov_b32 s35, 65536
    s_cselect_b32 s34, 32768, s34
    s_cselect_b32 s35, 99328, s35
    s_bitcmp1_b32 s99, 1
    s_cselect_b32 s80, s35, s34
    s_lshl_b32 s32, s37, 10
    s_add_u32 s80, s80, s32
    s_cmp_lg_u32 s3, 0
    s_cbranch_scc1 L_p2_a
    s_lshr_b32 s32, s76, 1
    s_lshl_b32 s32, s32, 11
    s_add_u32 s32, s32, 98304
    s_mov_b32 exec_lo, 0xffff
    s_mov_b32 exec_hi, 0x0
    s_mov_b32 s33, 0
L_poll_11:
    buffer_load_dword v10, v126, s[8:11], s32 offen sc1
    s_waitcnt vmcnt(0)
    v_cmp_ne_u32 vcc, s4, v10
    s_cbranch_vccz L_got_12
    s_add_u32 s33, s33, 1
    s_cmp_lt_u32 s33, 100000
    s_cbranch_scc1 L_poll_11
L_got_12:
    s_mov_b64 exec, -1
L_p2_a:
    s_barrier
    s_mov_b32 m0, s39
    s_nop 0
    buffer_load_dwordx4 v2, s[8:11], s38 offen sc1 lds
    buffer_load_dwordx4 v[12:15], v2, s[8:11], s42 offen sc1
    s_barrier
    buffer_load_dwordx4 v[16:19], v2, s[8:11], s43 offen sc1
    s_add_u32 m0, s39, s45
    s_nop 0
    buffer_load_dwordx4 v2, s[8:11], s38 offen offset:2048 sc1 lds
    s_add_u32 s39, s39, s48
    s_add_u32 s38, s38, 4096
    ds_write_b128 v124, v[24:27]
    ds_write_b128 v124, v[28:31] offset:16
    s_waitcnt vmcnt(2) lgkmcnt(0)
    s_barrier
    ds_read_b128 v[20:23], v4
    ds_read_b128 v[24:27], v5
    s_waitcnt lgkmcnt(1)
    v_mfma_f32_32x32x16_bf16 v[32:47], v[20:23], v[12:15], 0
    s_mov_b32 m0, s39
    s_nop 0
    buffer_load_dwordx4 v2, s[8:11], s38 offen sc1 lds
    s_nop 8
L_att0:
    v_exp_f32 v32, v32
    v_exp_f32 v33, v33
    v_smfmac_f32_32x32x32_bf16 v[80:95], v[28:31], v[56:63], v9
    ds_read_b128 v[28:31], v6 offset:0
    v_exp_f32 v34, v34
    v_exp_f32 v35, v35
    v_exp_f32 v36, v36
    v_exp_f32 v37, v37
    s_waitcnt vmcnt(2)
    v_mfma_f32_32x32x16_bf16 v[48:63], v[20:23], v[16:19], 0
    ds_read_b128 v[20:23], v4 offset:1024
    v_exp_f32 v38, v38
    v_exp_f32 v39, v39
    v_exp_f32 v40, v40
    v_exp_f32 v41, v41
    v_exp_f32 v42, v42
    s_waitcnt lgkmcnt(2)
    v_smfmac_f32_32x32x32_bf16 v[64:79], v[24:27], v[32:39], v9
    v_exp_f32 v43, v43
    s_add_u32 m0, s39, s45
    v_exp_f32 v44, v44
    buffer_load_dwordx4 v2, s[8:11], s38 offen offset:2048 sc1 lds
    s_add_u32 s39, s39, s48
    s_add_u32 s38, s38, 4096
    v_exp_f32 v45, v45
    v_exp_f32 v46, v46
    v_exp_f32 v47, v47
    v_exp_f32 v48, v48
    v_exp_f32 v49, v49
    s_waitcnt lgkmcnt(0)
    v_smfmac_f32_32x32x32_bf16 v[64:79], v[28:31], v[40:47], v9
    v_exp_f32 v50, v50
    v_exp_f32 v51, v51
    v_exp_f32 v52, v52
    v_exp_f32 v53, v53
    v_mfma_f32_32x32x16_bf16 v[32:47], v[20:23], v[12:15], 0
    v_exp_f32 v54, v54
    v_exp_f32 v55, v55
    v_exp_f32 v56, v56
    v_exp_f32 v57, v57
    v_exp_f32 v58, v58
    v_smfmac_f32_32x32x32_bf16 v[80:95], v[24:27], v[48:55], v9
    ds_read_b128 v[24:27], v5 offset:1056
    v_exp_f32 v59, v59
    s_mov_b32 m0, s39
    v_exp_f32 v60, v60
    buffer_load_dwordx4 v2, s[8:11], s38 offen sc1 lds
    v_exp_f32 v61, v61
    v_exp_f32 v62, v62
    v_exp_f32 v63, v63
    s_waitcnt vmcnt(3)
    s_barrier
    v_exp_f32 v32, v32
    v_exp_f32 v33, v33
    v_smfmac_f32_32x32x32_bf16 v[80:95], v[28:31], v[56:63], v9
    ds_read_b128 v[28:31], v6 offset:1056
    v_exp_f32 v34, v34
    s_add_u32 m0, s95, 8192
    v_exp_f32 v35, v35
    buffer_load_dwordx4 v120, s[24:27], s92 offen lds
    v_exp_f32 v36, v36
    v_exp_f32 v37, v37
    v_mfma_f32_32x32x16_bf16 v[48:63], v[20:23], v[16:19], 0
    ds_read_b128 v[20:23], v4 offset:2048
    v_exp_f32 v38, v38
    v_exp_f32 v39, v39
    v_exp_f32 v40, v40
    v_exp_f32 v41, v41
    v_exp_f32 v42, v42
    s_waitcnt lgkmcnt(2)
    v_smfmac_f32_32x32x32_bf16 v[64:79], v[24:27], v[32:39], v9
    v_exp_f32 v43, v43
    v_exp_f32 v44, v44
    v_exp_f32 v45, v45
    v_exp_f32 v46, v46
    v_exp_f32 v47, v47
    v_exp_f32 v48, v48
    v_exp_f32 v49, v49
    s_waitcnt lgkmcnt(0)
    v_smfmac_f32_32x32x32_bf16 v[64:79], v[28:31], v[40:47], v9
    v_exp_f32 v50, v50
    s_mov_b32 m0, s95
    v_exp_f32 v51, v51
    buffer_load_dwordx4 v116, s[20:23], s90 offen lds
    v_exp_f32 v52, v52
    v_exp_f32 v53, v53
    v_mfma_f32_32x32x16_bf16 v[32:47], v[20:23], v[12:15], 0
    v_exp_f32 v54, v54
    v_exp_f32 v55, v55
    v_exp_f32 v56, v56
    v_exp_f32 v57, v57
    v_exp_f32 v58, v58
    v_smfmac_f32_32x32x32_bf16 v[80:95], v[24:27], v[48:55], v9
    ds_read_b128 v[24:27], v5 offset:2112
    v_exp_f32 v59, v59
    v_exp_f32 v60, v60
    buffer_load_dwordx2 v[110:111], v114, s[8:11], s94 offen sc1
    v_exp_f32 v61, v61
    v_exp_f32 v62, v62
    v_exp_f32 v63, v63
    s_waitcnt vmcnt(5)
    s_barrier
    v_exp_f32 v32, v32
    v_exp_f32 v33, v33
    v_smfmac_f32_32x32x32_bf16 v[80:95], v[28:31], v[56:63], v9
    ds_read_b128 v[28:31], v6 offset:2112
    v_exp_f32 v34, v34
    v_exp_f32 v35, v35
    v_exp_f32 v36, v36
    v_exp_f32 v37, v37
    v_mfma_f32_32x32x16_bf16 v[48:63], v[20:23], v[16:19], 0
    ds_read_b128 v[20:23], v4 offset:3072
    v_exp_f32 v38, v38
    v_exp_f32 v39, v39
    v_exp_f32 v40, v40
    v_exp_f32 v41, v41
    v_exp_f32 v42, v42
    s_waitcnt lgkmcnt(2)
    v_smfmac_f32_32x32x32_bf16 v[64:79], v[24:27], v[32:39], v9
    v_exp_f32 v43, v43
    s_add_u32 m0, s39, s45
    v_exp_f32 v44, v44
    buffer_load_dwordx4 v2, s[8:11], s38 offen offset:2048 sc1 lds
    s_add_u32 s39, s39, s48
    s_add_u32 s38, s38, 4096
    v_exp_f32 v45, v45
    v_exp_f32 v46, v46
    v_exp_f32 v47, v47
    v_exp_f32 v48, v48
    v_exp_f32 v49, v49
    s_waitcnt lgkmcnt(0)
    v_smfmac_f32_32x32x32_bf16 v[64:79], v[28:31], v[40:47], v9
    v_exp_f32 v50, v50
    v_exp_f32 v51, v51
    v_exp_f32 v52, v52
    v_exp_f32 v53, v53
    v_mfma_f32_32x32x16_bf16 v[32:47], v[20:23], v[12:15], 0
    v_exp_f32 v54, v54
    v_exp_f32 v55, v55
    v_exp_f32 v56, v56
    v_exp_f32 v57, v57
    v_exp_f32 v58, v58
    v_smfmac_f32_32x32x32_bf16 v[80:95], v[24:27], v[48:55], v9
    ds_read_b128 v[24:27], v5 offset:3168
    v_exp_f32 v59, v59
    v_exp_f32 v60, v60
    v_exp_f32 v61, v61
    v_exp_f32 v62, v62
    v_exp_f32 v63, v63
    v_exp_f32 v32, v32
    v_exp_f32 v33, v33
    v_smfmac_f32_32x32x32_bf16 v[80:95], v[28:31], v[56:63], v9
    ds_read_b128 v[28:31], v6 offset:3168
    v_exp_f32 v34, v34
    v_exp_f32 v35, v35
    v_exp_f32 v36, v36
    v_exp_f32 v37, v37
    v_mfma_f32_32x32x16_bf16 v[48:63], v[20:23], v[16:19], 0
    ds_read_b128 v[20:23], v4 offset:4096
    v_exp_f32 v38, v38
    v_exp_f32 v39, v39
    v_exp_f32 v40, v40
    v_exp_f32 v41, v41
    v_exp_f32 v42, v42
    s_waitcnt lgkmcnt(2)
    v_smfmac_f32_32x32x32_bf16 v[64:79], v[24:27], v[32:39], v9
    v_exp_f32 v43, v43
    v_exp_f32 v44, v44
    v_exp_f32 v45, v45
    v_exp_f32 v46, v46
    v_exp_f32 v47, v47
    v_exp_f32 v48, v48
    v_exp_f32 v49, v49
    s_waitcnt lgkmcnt(0)
    v_smfmac_f32_32x32x32_bf16 v[64:79], v[28:31], v[40:47], v9
    v_exp_f32 v50, v50
    v_exp_f32 v51, v51
    v_exp_f32 v52, v52
    v_exp_f32 v53, v53
    v_mfma_f32_32x32x16_bf16 v[32:47], v[20:23], v[12:15], 0
    v_exp_f32 v54, v54
    v_exp_f32 v55, v55
    v_exp_f32 v56, v56
    v_exp_f32 v57, v57
    v_exp_f32 v58, v58
    v_smfmac_f32_32x32x32_bf16 v[80:95], v[24:27], v[48:55], v9
    ds_read_b128 v[24:27], v5 offset:4224
    v_exp_f32 v59, v59
    v_exp_f32 v60, v60
    v_exp_f32 v61, v61
    v_exp_f32 v62, v62
    v_exp_f32 v63, v63
    s_waitcnt vmcnt(5)
    s_barrier
    v_exp_f32 v32, v32
    v_exp_f32 v33, v33
    v_smfmac_f32_32x32x32_bf16 v[80:95], v[28:31], v[56:63], v9
    ds_read_b128 v[28:31], v6 offset:4224
    v_exp_f32 v34, v34
    v_exp_f32 v35, v35
    v_exp_f32 v36, v36
    v_exp_f32 v37, v37
    v_mfma_f32_32x32x16_bf16 v[48:63], v[20:23], v[16:19], 0
    ds_read_b128 v[20:23], v4 offset:5120
    v_exp_f32 v38, v38
    v_exp_f32 v39, v39
    v_exp_f32 v40, v40
    v_exp_f32 v41, v41
    v_exp_f32 v42, v42
    s_waitcnt lgkmcnt(2)
    v_smfmac_f32_32x32x32_bf16 v[64:79], v[24:27], v[32:39], v9
    v_exp_f32 v43, v43
    s_mov_b32 m0, s39
    v_exp_f32 v44, v44
    buffer_load_dwordx4 v2, s[8:11], s38 offen sc1 lds
    v_exp_f32 v45, v45
    v_exp_f32 v46, v46
    v_exp_f32 v47, v47
    v_exp_f32 v48, v48
    v_exp_f32 v49, v49
    s_waitcnt lgkmcnt(0)
    v_smfmac_f32_32x32x32_bf16 v[64:79], v[28:31], v[40:47], v9
    v_exp_f32 v50, v50
    v_exp_f32 v51, v51
    v_exp_f32 v52, v52
    v_exp_f32 v53, v53
    v_mfma_f32_32x32x16_bf16 v[32:47], v[20:23], v[12:15], 0
    v_exp_f32 v54, v54
    v_exp_f32 v55, v55
    v_exp_f32 v56, v56
    v_exp_f32 v57, v57
    v_exp_f32 v58, v58
    v_smfmac_f32_32x32x32_bf16 v[80:95], v[24:27], v[48:55], v9
    ds_read_b128 v[24:27], v5 offset:5280
    v_exp_f32 v59, v59
    v_exp_f32 v60, v60
    v_exp_f32 v61, v61
    v_exp_f32 v62, v62
    v_exp_f32 v63, v63
    v_exp_f32 v32, v32
    v_exp_f32 v33, v33
    v_smfmac_f32_32x32x32_bf16 v[80:95], v[28:31], v[56:63], v9
    ds_read_b128 v[28:31], v6 offset:5280
    v_exp_f32 v34, v34
    v_exp_f32 v35, v35
    v_exp_f32 v36, v36
    v_exp_f32 v37, v37
    v_mfma_f32_32x32x16_bf16 v[48:63], v[20:23], v[16:19], 0
    ds_read_b128 v[20:23], v4 offset:6144
    v_exp_f32 v38, v38
    v_exp_f32 v39, v39
    v_exp_f32 v40, v40
    v_exp_f32 v41, v41
    v_exp_f32 v42, v42
    s_waitcnt lgkmcnt(2)
    v_smfmac_f32_32x32x32_bf16 v[64:79], v[24:27], v[32:39], v9
    v_exp_f32 v43, v43
    v_exp_f32 v44, v44
    v_exp_f32 v45, v45
    v_exp_f32 v46, v46
    v_exp_f32 v47, v47
    v_exp_f32 v48, v48
    v_exp_f32 v49, v49
    s_waitcnt lgkmcnt(0)
    v_smfmac_f32_32x32x32_bf16 v[64:79], v[28:31], v[40:47], v9
    v_exp_f32 v50, v50
    v_exp_f32 v51, v51
    v_exp_f32 v52, v52
    v_exp_f32 v53, v53
    v_mfma_f32_32x32x16_bf16 v[32:47], v[20:23], v[12:15], 0
    v_exp_f32 v54, v54
    v_exp_f32 v55, v55
    v_exp_f32 v56, v56
    v_exp_f32 v57, v57
    v_exp_f32 v58, v58
    v_smfmac_f32_32x32x32_bf16 v[80:95], v[24:27], v[48:55], v9
    ds_read_b128 v[24:27], v5 offset:6336
    v_exp_f32 v59, v59
    v_exp_f32 v60, v60
    v_exp_f32 v61, v61
    v_exp_f32 v62, v62
    v_exp_f32 v63, v63
    s_waitcnt vmcnt(2)
    s_barrier
    v_exp_f32 v32, v32
    v_exp_f32 v33, v33
    v_smfmac_f32_32x32x32_bf16 v[80:95], v[28:31], v[56:63], v9
    ds_read_b128 v[28:31], v6 offset:6336
    v_exp_f32 v34, v34
    v_exp_f32 v35, v35
    v_exp_f32 v36, v36
    v_exp_f32 v37, v37
    v_mfma_f32_32x32x16_bf16 v[48:63], v[20:23], v[16:19], 0
    ds_read_b128 v[20:23], v4 offset:7168
    v_exp_f32 v38, v38
    v_exp_f32 v39, v39
    v_exp_f32 v40, v40
    v_exp_f32 v41, v41
    v_exp_f32 v42, v42
    s_waitcnt lgkmcnt(2)
    v_smfmac_f32_32x32x32_bf16 v[64:79], v[24:27], v[32:39], v9
    v_exp_f32 v43, v43
    s_add_u32 m0, s39, s45
    v_exp_f32 v44, v44
    buffer_load_dwordx4 v2, s[8:11], s38 offen offset:2048 sc1 lds
    s_add_u32 s39, s39, s48
    s_add_u32 s38, s38, 4096
    v_cmp_ne_u32 vcc, s4, v111
    s_and_b64 vcc, vcc, 0xffff
    s_cbranch_vccnz L_gs_13
L_gsok_14:
    ds_write_b32 v115, v110
    ds_read_b64_tr_b16 v[120:121], v119 offset:8192
    ds_read_b64_tr_b16 v[122:123], v119 offset:9216
    ds_read_b64_tr_b16 v[116:117], v119
    ds_read_b64_tr_b16 v[118:119], v119 offset:1024
    ds_read_b64 v[100:101], v113
    ds_read_b64 v[102:103], v113 offset:16
    ds_read_b64 v[108:109], v113 offset:32
    ds_read_b64 v[110:111], v113 offset:48
    v_exp_f32 v45, v45
    v_exp_f32 v46, v46
    v_exp_f32 v47, v47
    v_exp_f32 v48, v48
    v_exp_f32 v49, v49
    s_waitcnt lgkmcnt(0)
    v_smfmac_f32_32x32x32_bf16 v[64:79], v[28:31], v[40:47], v9
    v_exp_f32 v50, v50
    v_exp_f32 v51, v51
    buffer_store_dwordx4 v[120:123], v2, s[8:11], s93 offen sc1
    v_exp_f32 v52, v52
    v_exp_f32 v53, v53
    v_mfma_f32_32x32x16_bf16 v[32:47], v[20:23], v[12:15], 0
    v_exp_f32 v54, v54
    v_exp_f32 v55, v55
    v_exp_f32 v56, v56
    v_exp_f32 v57, v57
    v_exp_f32 v58, v58
    v_smfmac_f32_32x32x32_bf16 v[80:95], v[24:27], v[48:55], v9
    ds_read_b128 v[24:27], v5 offset:7392
    v_exp_f32 v59, v59
    v_exp_f32 v60, v60
    v_mfma_f32_32x32x16_bf16 a[0:15], v[100:103], v[116:119], 0
    v_exp_f32 v61, v61
    v_exp_f32 v62, v62
    v_exp_f32 v63, v63
    v_exp_f32 v32, v32
    v_exp_f32 v33, v33
    v_smfmac_f32_32x32x32_bf16 v[80:95], v[28:31], v[56:63], v9
    ds_read_b128 v[28:31], v6 offset:7392
    v_exp_f32 v34, v34
    v_exp_f32 v35, v35
    v_lshlrev_b32 v10, 16, v116
    v_and_b32 v11, 0xffff0000, v116
    v_lshlrev_b32 v104, 16, v108
    v_and_b32 v105, 0xffff0000, v108
    v_pk_mul_f32 v[10:11], v[10:11], v[104:105]
    v_mov_b32 v100, 0x3f803f80
    v_cvt_pk_bf16_f32 v10, v10, v11
    v_cndmask_b32 v116, v116, v10, s[40:41]
    v_lshlrev_b32 v10, 16, v117
    v_and_b32 v11, 0xffff0000, v117
    v_lshlrev_b32 v104, 16, v109
    v_and_b32 v105, 0xffff0000, v109
    v_pk_mul_f32 v[10:11], v[10:11], v[104:105]
    v_mov_b32 v101, 0x3f803f80
    v_cvt_pk_bf16_f32 v10, v10, v11
    v_cndmask_b32 v117, v117, v10, s[40:41]
    v_exp_f32 v36, v36
    v_exp_f32 v37, v37
    v_mfma_f32_32x32x16_bf16 v[48:63], v[20:23], v[16:19], 0
    ds_read_b128 v[20:23], v4 offset:8192
    v_exp_f32 v38, v38
    v_exp_f32 v39, v39
    v_exp_f32 v40, v40
    v_exp_f32 v41, v41
    v_exp_f32 v42, v42
    s_waitcnt lgkmcnt(2)
    v_smfmac_f32_32x32x32_bf16 v[64:79], v[24:27], v[32:39], v9
    v_exp_f32 v43, v43
    v_exp_f32 v44, v44
    v_lshlrev_b32 v10, 16, v118
    v_and_b32 v11, 0xffff0000, v118
    v_lshlrev_b32 v104, 16, v110
    v_and_b32 v105, 0xffff0000, v110
    v_pk_mul_f32 v[10:11], v[10:11], v[104:105]
    v_mov_b32 v102, 0x3f803f80
    v_cvt_pk_bf16_f32 v10, v10, v11
    v_cndmask_b32 v118, v118, v10, s[40:41]
    v_lshlrev_b32 v10, 16, v119
    v_and_b32 v11, 0xffff0000, v119
    v_lshlrev_b32 v104, 16, v111
    v_and_b32 v105, 0xffff0000, v111
    v_pk_mul_f32 v[10:11], v[10:11], v[104:105]
    v_mov_b32 v103, 0x3f803f80
    v_cvt_pk_bf16_f32 v10, v10, v11
    v_cndmask_b32 v119, v119, v10, s[40:41]
    v_exp_f32 v45, v45
    v_exp_f32 v46, v46
    v_exp_f32 v47, v47
    v_exp_f32 v48, v48
    v_exp_f32 v49, v49
    s_waitcnt lgkmcnt(0)
    v_smfmac_f32_32x32x32_bf16 v[64:79], v[28:31], v[40:47], v9
    v_exp_f32 v50, v50
    v_exp_f32 v51, v51
    buffer_store_dwordx4 v[116:119], v2, s[8:11], s91 offen sc1
    v_exp_f32 v52, v52
    v_exp_f32 v53, v53
    v_mfma_f32_32x32x16_bf16 v[32:47], v[20:23], v[12:15], 0
    v_exp_f32 v54, v54
    v_exp_f32 v55, v55
    v_exp_f32 v56, v56
    v_exp_f32 v57, v57
    v_exp_f32 v58, v58
    v_smfmac_f32_32x32x32_bf16 v[80:95], v[24:27], v[48:55], v9
    ds_read_b128 v[24:27], v5 offset:8448
    v_exp_f32 v59, v59
    v_exp_f32 v60, v60
    v_mfma_f32_32x32x16_bf16 a[16:31], v[100:103], v[116:119], 0
    v_exp_f32 v61, v61
    v_exp_f32 v62, v62
    v_exp_f32 v63, v63
    s_waitcnt vmcnt(4)
    s_barrier
    v_exp_f32 v32, v32
    v_exp_f32 v33, v33
    v_smfmac_f32_32x32x32_bf16 v[80:95], v[28:31], v[56:63], v9
    ds_read_b128 v[28:31], v6 offset:8448
    v_exp_f32 v34, v34
    v_exp_f32 v35, v35
    v_exp_f32 v36, v36
    v_exp_f32 v37, v37
    v_mfma_f32_32x32x16_bf16 v[48:63], v[20:23], v[16:19], 0
    ds_read_b128 v[20:23], v4 offset:9216
    v_exp_f32 v38, v38
    v_exp_f32 v39, v39
    v_exp_f32 v40, v40
    v_exp_f32 v41, v41
    v_exp_f32 v42, v42
    s_waitcnt lgkmcnt(2)
    v_smfmac_f32_32x32x32_bf16 v[64:79], v[24:27], v[32:39], v9
    v_exp_f32 v43, v43
    s_mov_b32 m0, s39
    v_exp_f32 v44, v44
    buffer_load_dwordx4 v2, s[8:11], s38 offen sc1 lds
    v_exp_f32 v45, v45
    v_exp_f32 v46, v46
    v_exp_f32 v47, v47
    v_exp_f32 v48, v48
    v_exp_f32 v49, v49
    s_waitcnt lgkmcnt(0)
    v_smfmac_f32_32x32x32_bf16 v[64:79], v[28:31], v[40:47], v9
    v_exp_f32 v50, v50
    v_exp_f32 v51, v51
    v_exp_f32 v52, v52
    v_exp_f32 v53, v53
    v_mfma_f32_32x32x16_bf16 v[32:47], v[20:23], v[12:15], 0
    v_exp_f32 v54, v54
    v_exp_f32 v55, v55
    v_exp_f32 v56, v56
    v_exp_f32 v57, v57
    v_exp_f32 v58, v58
    v_smfmac_f32_32x32x32_bf16 v[80:95], v[24:27], v[48:55], v9
    ds_read_b128 v[24:27], v5 offset:9504
    v_exp_f32 v59, v59
    v_exp_f32 v60, v60
    v_exp_f32 v61, v61
    v_exp_f32 v62, v62
    v_exp_f32 v63, v63
    v_exp_f32 v32, v32
    v_exp_f32 v33, v33
    v_smfmac_f32_32x32x32_bf16 v[80:95], v[28:31], v[56:63], v9
    ds_read_b128 v[28:31], v6 offset:9504
    v_exp_f32 v34, v34
    v_exp_f32 v35, v35
    v_exp_f32 v36, v36
    v_exp_f32 v37, v37
    v_mfma_f32_32x32x16_bf16 v[48:63], v[20:23], v[16:19], 0
    ds_read_b128 v[20:23], v4 offset:10240
    v_exp_f32 v38, v38
    v_exp_f32 v39, v39
    v_exp_f32 v40, v40
    v_exp_f32 v41, v41
    v_exp_f32 v42, v42
    s_waitcnt lgkmcnt(2)
    v_smfmac_f32_32x32x32_bf16 v[64:79], v[24:27], v[32:39], v9
    v_exp_f32 v43, v43
    v_exp_f32 v44, v44
    ds_write_b32 v98, a16
    ds_write_b32 v98, a0 offset:128
    v_exp_f32 v45, v45
    v_exp_f32 v46, v46
    v_exp_f32 v47, v47
    v_exp_f32 v48, v48
    v_exp_f32 v49, v49
    s_waitcnt lgkmcnt(0)
    v_smfmac_f32_32x32x32_bf16 v[64:79], v[28:31], v[40:47], v9
    v_exp_f32 v50, v50
    v_exp_f32 v51, v51
    v_exp_f32 v52, v52
    v_exp_f32 v53, v53
    v_mfma_f32_32x32x16_bf16 v[32:47], v[20:23], v[12:15], 0
    v_exp_f32 v54, v54
    v_exp_f32 v55, v55
    v_exp_f32 v56, v56
    v_exp_f32 v57, v57
    v_exp_f32 v58, v58
    v_smfmac_f32_32x32x32_bf16 v[80:95], v[24:27], v[48:55], v9
    ds_read_b128 v[24:27], v5 offset:10560
    v_exp_f32 v59, v59
    v_exp_f32 v60, v60
    v_exp_f32 v61, v61
    v_exp_f32 v62, v62
    v_exp_f32 v63, v63
    s_waitcnt vmcnt(1)
    s_barrier
    v_exp_f32 v32, v32
    v_exp_f32 v33, v33
    v_smfmac_f32_32x32x32_bf16 v[80:95], v[28:31], v[56:63], v9
    ds_read_b128 v[28:31], v6 offset:10560
    v_exp_f32 v34, v34
    v_exp_f32 v35, v35
    v_exp_f32 v36, v36
    v_exp_f32 v37, v37
    v_mfma_f32_32x32x16_bf16 v[48:63], v[20:23], v[16:19], 0
    ds_read_b128 v[20:23], v4 offset:11264
    v_exp_f32 v38, v38
    v_exp_f32 v39, v39
    v_exp_f32 v40, v40
    v_exp_f32 v41, v41
    v_exp_f32 v42, v42
    s_waitcnt lgkmcnt(2)
    v_smfmac_f32_32x32x32_bf16 v[64:79], v[24:27], v[32:39], v9
    v_exp_f32 v43, v43
    s_add_u32 m0, s39, s45
    v_exp_f32 v44, v44
    buffer_load_dwordx4 v2, s[8:11], s38 offen offset:2048 sc1 lds
    s_add_u32 s39, s39, s48
    s_add_u32 s38, s38, 4096
    ds_read_b32 v100, v99 offset:0
    ds_read_b32 v101, v99 offset:512
    ds_read_b32 v102, v99 offset:1024
    ds_read_b32 v103, v99 offset:1536
    v_exp_f32 v45, v45
    v_exp_f32 v46, v46
    v_exp_f32 v47, v47
    v_exp_f32 v48, v48
    v_exp_f32 v49, v49
    s_waitcnt lgkmcnt(0)
    v_smfmac_f32_32x32x32_bf16 v[64:79], v[28:31], v[40:47], v9
    v_exp_f32 v50, v50
    v_exp_f32 v51, v51
    v_add_f32 v100, v100, v101
    v_add_f32 v102, v102, v103
    v_add_f32 v100, v100, v102
    buffer_store_dword v100, v3, s[8:11], s81 offen sc1
    v_exp_f32 v52, v52
    v_exp_f32 v53, v53
    v_mfma_f32_32x32x16_bf16 v[32:47], v[20:23], v[12:15], 0
    v_exp_f32 v54, v54
    v_exp_f32 v55, v55
    v_exp_f32 v56, v56
    v_exp_f32 v57, v57
    v_exp_f32 v58, v58
    v_smfmac_f32_32x32x32_bf16 v[80:95], v[24:27], v[48:55], v9
    ds_read_b128 v[24:27], v5 offset:11616
    v_exp_f32 v59, v59
    v_exp_f32 v60, v60
    v_exp_f32 v61, v61
    v_exp_f32 v62, v62
    v_exp_f32 v63, v63
    v_exp_f32 v32, v32
    v_exp_f32 v33, v33
    v_smfmac_f32_32x32x32_bf16 v[80:95], v[28:31], v[56:63], v9
    ds_read_b128 v[28:31], v6 offset:11616
    v_exp_f32 v34, v34
    v_exp_f32 v35, v35
    v_exp_f32 v36, v36
    v_exp_f32 v37, v37
    v_mfma_f32_32x32x16_bf16 v[48:63], v[20:23], v[16:19], 0
    ds_read_b128 v[20:23], v4 offset:12288
    v_exp_f32 v38, v38
    v_exp_f32 v39, v39
    v_exp_f32 v40, v40
    v_exp_f32 v41, v41
    v_exp_f32 v42, v42
    s_waitcnt lgkmcnt(2)
    v_smfmac_f32_32x32x32_bf16 v[64:79], v[24:27], v[32:39], v9
    v_exp_f32 v43, v43
    v_exp_f32 v44, v44
    v_exp_f32 v45, v45
    v_exp_f32 v46, v46
    v_exp_f32 v47, v47
    v_exp_f32 v48, v48
    v_exp_f32 v49, v49
    s_waitcnt lgkmcnt(0)
    v_smfmac_f32_32x32x32_bf16 v[64:79], v[28:31], v[40:47], v9
    v_exp_f32 v50, v50
    v_exp_f32 v51, v51
    v_exp_f32 v52, v52
    v_exp_f32 v53, v53
    v_mfma_f32_32x32x16_bf16 v[32:47], v[20:23], v[12:15], 0
    v_exp_f32 v54, v54
    v_exp_f32 v55, v55
    v_exp_f32 v56, v56
    v_exp_f32 v57, v57
    v_exp_f32 v58, v58
    v_smfmac_f32_32x32x32_bf16 v[80:95], v[24:27], v[48:55], v9
    ds_read_b128 v[24:27], v5 offset:12672
    v_exp_f32 v59, v59
    v_exp_f32 v60, v60
    v_exp_f32 v61, v61
    v_exp_f32 v62, v62
    v_exp_f32 v63, v63
    s_waitcnt vmcnt(0)
    s_barrier
    v_exp_f32 v32, v32
    v_exp_f32 v33, v33
    v_smfmac_f32_32x32x32_bf16 v[80:95], v[28:31], v[56:63], v9
    ds_read_b128 v[28:31], v6 offset:12672
    v_exp_f32 v34, v34
    v_exp_f32 v35, v35
    buffer_store_dwordx2 v[96:97], v0, s[8:11], s84 offen sc1
    v_exp_f32 v36, v36
    v_exp_f32 v37, v37
    v_mfma_f32_32x32x16_bf16 v[48:63], v[20:23], v[16:19], 0
    ds_read_b128 v[20:23], v4 offset:13312
    v_exp_f32 v38, v38
    v_exp_f32 v39, v39
    v_exp_f32 v40, v40
    v_exp_f32 v41, v41
    v_exp_f32 v42, v42
    s_waitcnt lgkmcnt(2)
    v_smfmac_f32_32x32x32_bf16 v[64:79], v[24:27], v[32:39], v9
    v_exp_f32 v43, v43
    s_mov_b32 m0, s39
    v_exp_f32 v44, v44
    buffer_load_dwordx4 v2, s[8:11], s38 offen sc1 lds
    v_exp_f32 v45, v45
    v_exp_f32 v46, v46
    v_exp_f32 v47, v47
    v_exp_f32 v48, v48
    v_exp_f32 v49, v49
    s_waitcnt lgkmcnt(0)
    v_smfmac_f32_32x32x32_bf16 v[64:79], v[28:31], v[40:47], v9
    v_exp_f32 v50, v50
    v_exp_f32 v51, v51
    v_exp_f32 v52, v52
    v_exp_f32 v53, v53
    v_mfma_f32_32x32x16_bf16 v[32:47], v[20:23], v[12:15], 0
    v_exp_f32 v54, v54
    v_exp_f32 v55, v55
    v_exp_f32 v56, v56
    v_exp_f32 v57, v57
    v_exp_f32 v58, v58
    v_smfmac_f32_32x32x32_bf16 v[80:95], v[24:27], v[48:55], v9
    ds_read_b128 v[24:27], v5 offset:13728
    v_exp_f32 v59, v59
    v_exp_f32 v60, v60
    v_exp_f32 v61, v61
    v_exp_f32 v62, v62
    v_exp_f32 v63, v63
    v_exp_f32 v32, v32
    v_exp_f32 v33, v33
    v_smfmac_f32_32x32x32_bf16 v[80:95], v[28:31], v[56:63], v9
    ds_read_b128 v[28:31], v6 offset:13728
    v_exp_f32 v34, v34
    v_exp_f32 v35, v35
    v_exp_f32 v36, v36
    v_exp_f32 v37, v37
    v_mfma_f32_32x32x16_bf16 v[48:63], v[20:23], v[16:19], 0
    ds_read_b128 v[20:23], v4 offset:14336
    v_exp_f32 v38, v38
    v_exp_f32 v39, v39
    v_exp_f32 v40, v40
    v_exp_f32 v41, v41
    v_exp_f32 v42, v42
    s_waitcnt lgkmcnt(2)
    v_smfmac_f32_32x32x32_bf16 v[64:79], v[24:27], v[32:39], v9
    v_exp_f32 v43, v43
    v_exp_f32 v44, v44
    v_exp_f32 v45, v45
    v_exp_f32 v46, v46
    v_exp_f32 v47, v47
    v_exp_f32 v48, v48
    v_exp_f32 v49, v49
    s_waitcnt lgkmcnt(0)
    v_smfmac_f32_32x32x32_bf16 v[64:79], v[28:31], v[40:47], v9
    v_exp_f32 v50, v50
    v_exp_f32 v51, v51
    v_exp_f32 v52, v52
    v_exp_f32 v53, v53
    v_mfma_f32_32x32x16_bf16 v[32:47], v[20:23], v[12:15], 0
    v_exp_f32 v54, v54
    v_exp_f32 v55, v55
    v_exp_f32 v56, v56
    v_exp_f32 v57, v57
    v_exp_f32 v58, v58
    v_smfmac_f32_32x32x32_bf16 v[80:95], v[24:27], v[48:55], v9
    ds_read_b128 v[24:27], v5 offset:14784
    v_exp_f32 v59, v59
    v_exp_f32 v60, v60
    v_exp_f32 v61, v61
    v_exp_f32 v62, v62
    v_exp_f32 v63, v63
    s_waitcnt vmcnt(4)
    s_barrier
    v_exp_f32 v32, v32
    v_exp_f32 v33, v33
    v_smfmac_f32_32x32x32_bf16 v[80:95], v[28:31], v[56:63], v9
    ds_read_b128 v[28:31], v6 offset:14784
    v_exp_f32 v34, v34
    v_exp_f32 v35, v35
    v_exp_f32 v36, v36
    v_exp_f32 v37, v37
    v_mfma_f32_32x32x16_bf16 v[48:63], v[20:23], v[16:19], 0
    ds_read_b128 v[20:23], v4 offset:15360
    v_exp_f32 v38, v38
    v_exp_f32 v39, v39
    v_exp_f32 v40, v40
    v_exp_f32 v41, v41
    v_exp_f32 v42, v42
    s_waitcnt lgkmcnt(2)
    v_smfmac_f32_32x32x32_bf16 v[64:79], v[24:27], v[32:39], v9
    v_exp_f32 v43, v43
    s_add_u32 m0, s39, s45
    v_exp_f32 v44, v44
    buffer_load_dwordx4 v2, s[8:11], s38 offen offset:2048 sc1 lds
    s_add_u32 s39, s39, s48
    s_add_u32 s38, s38, 4096
    v_exp_f32 v45, v45
    v_exp_f32 v46, v46
    v_exp_f32 v47, v47
    v_exp_f32 v48, v48
    v_exp_f32 v49, v49
    s_waitcnt lgkmcnt(0)
    v_smfmac_f32_32x32x32_bf16 v[64:79], v[28:31], v[40:47], v9
    v_exp_f32 v50, v50
    v_exp_f32 v51, v51
    v_exp_f32 v52, v52
    v_exp_f32 v53, v53
    v_mfma_f32_32x32x16_bf16 v[32:47], v[20:23], v[12:15], 0
    v_exp_f32 v54, v54
    v_exp_f32 v55, v55
    v_exp_f32 v56, v56
    v_exp_f32 v57, v57
    v_exp_f32 v58, v58
    v_smfmac_f32_32x32x32_bf16 v[80:95], v[24:27], v[48:55], v9
    ds_read_b128 v[24:27], v5 offset:15840
    v_exp_f32 v59, v59
    v_exp_f32 v60, v60
    v_exp_f32 v61, v61
    v_exp_f32 v62, v62
    v_exp_f32 v63, v63
    v_exp_f32 v32, v32
    v_exp_f32 v33, v33
    v_smfmac_f32_32x32x32_bf16 v[80:95], v[28:31], v[56:63], v9
    ds_read_b128 v[28:31], v6 offset:15840
    v_exp_f32 v34, v34
    v_exp_f32 v35, v35
    v_exp_f32 v36, v36
    v_exp_f32 v37, v37
    v_mfma_f32_32x32x16_bf16 v[48:63], v[20:23], v[16:19], 0
    ds_read_b128 v[20:23], v4 offset:16384
    v_exp_f32 v38, v38
    v_exp_f32 v39, v39
    v_exp_f32 v40, v40
    v_exp_f32 v41, v41
    v_exp_f32 v42, v42
    s_waitcnt lgkmcnt(2)
    v_smfmac_f32_32x32x32_bf16 v[64:79], v[24:27], v[32:39], v9
    v_exp_f32 v43, v43
    v_exp_f32 v44, v44
    v_exp_f32 v45, v45
    v_exp_f32 v46, v46
    v_exp_f32 v47, v47
    v_exp_f32 v48, v48
    v_exp_f32 v49, v49
    s_waitcnt lgkmcnt(0)
    v_smfmac_f32_32x32x32_bf16 v[64:79], v[28:31], v[40:47], v9
    v_exp_f32 v50, v50
    v_exp_f32 v51, v51
    v_exp_f32 v52, v52
    v_exp_f32 v53, v53
    v_mfma_f32_32x32x16_bf16 v[32:47], v[20:23], v[12:15], 0
    v_exp_f32 v54, v54
    v_exp_f32 v55, v55
    v_exp_f32 v56, v56
    v_exp_f32 v57, v57
    v_exp_f32 v58, v58
    v_smfmac_f32_32x32x32_bf16 v[80:95], v[24:27], v[48:55], v9
    ds_read_b128 v[24:27], v5 offset:16896
    v_exp_f32 v59, v59
    v_exp_f32 v60, v60
    v_exp_f32 v61, v61
    v_exp_f32 v62, v62
    v_exp_f32 v63, v63
    s_waitcnt vmcnt(1)
    s_barrier
    v_exp_f32 v32, v32
    v_exp_f32 v33, v33
    v_smfmac_f32_32x32x32_bf16 v[80:95], v[28:31], v[56:63], v9
    ds_read_b128 v[28:31], v6 offset:16896
    v_exp_f32 v34, v34
    v_exp_f32 v35, v35
    v_exp_f32 v36, v36
    v_exp_f32 v37, v37
    v_mfma_f32_32x32x16_bf16 v[48:63], v[20:23], v[16:19], 0
    ds_read_b128 v[20:23], v4 offset:17408
    v_exp_f32 v38, v38
    v_exp_f32 v39, v39
    v_exp_f32 v40, v40
    v_exp_f32 v41, v41
    v_exp_f32 v42, v42
    s_waitcnt lgkmcnt(2)
    v_smfmac_f32_32x32x32_bf16 v[64:79], v[24:27], v[32:39], v9
    v_exp_f32 v43, v43
    s_mov_b32 m0, s39
    v_exp_f32 v44, v44
    buffer_load_dwordx4 v2, s[8:11], s38 offen sc1 lds
    v_exp_f32 v45, v45
    v_exp_f32 v46, v46
    v_exp_f32 v47, v47
    v_exp_f32 v48, v48
    v_exp_f32 v49, v49
    s_waitcnt lgkmcnt(0)
    v_smfmac_f32_32x32x32_bf16 v[64:79], v[28:31], v[40:47], v9
    v_exp_f32 v50, v50
    v_exp_f32 v51, v51
    v_exp_f32 v52, v52
    v_exp_f32 v53, v53
    v_mfma_f32_32x32x16_bf16 v[32:47], v[20:23], v[12:15], 0
    v_exp_f32 v54, v54
    v_exp_f32 v55, v55
    v_exp_f32 v56, v56
    v_exp_f32 v57, v57
    v_exp_f32 v58, v58
    v_smfmac_f32_32x32x32_bf16 v[80:95], v[24:27], v[48:55], v9
    ds_read_b128 v[24:27], v5 offset:17952
    v_exp_f32 v59, v59
    v_exp_f32 v60, v60
    buffer_load_dwordx2 v[112:113], v8, s[8:11], 0 offen sc1
    v_exp_f32 v61, v61
    v_exp_f32 v62, v62
    v_exp_f32 v63, v63
    v_exp_f32 v32, v32
    v_exp_f32 v33, v33
    v_smfmac_f32_32x32x32_bf16 v[80:95], v[28:31], v[56:63], v9
    ds_read_b128 v[28:31], v6 offset:17952
    v_exp_f32 v34, v34
    v_exp_f32 v35, v35
    v_exp_f32 v36, v36
    v_exp_f32 v37, v37
    v_mfma_f32_32x32x16_bf16 v[48:63], v[20:23], v[16:19], 0
    ds_read_b128 v[20:23], v4 offset:18432
    v_exp_f32 v38, v38
    v_exp_f32 v39, v39
    v_exp_f32 v40, v40
    v_exp_f32 v41, v41
    v_exp_f32 v42, v42
    s_waitcnt lgkmcnt(2)
    v_smfmac_f32_32x32x32_bf16 v[64:79], v[24:27], v[32:39], v9
    v_exp_f32 v43, v43
    v_exp_f32 v44, v44
    v_exp_f32 v45, v45
    v_exp_f32 v46, v46
    v_exp_f32 v47, v47
    v_exp_f32 v48, v48
    v_exp_f32 v49, v49
    s_waitcnt lgkmcnt(0)
    v_smfmac_f32_32x32x32_bf16 v[64:79], v[28:31], v[40:47], v9
    v_exp_f32 v50, v50
    v_exp_f32 v51, v51
    v_exp_f32 v52, v52
    v_exp_f32 v53, v53
    v_mfma_f32_32x32x16_bf16 v[32:47], v[20:23], v[12:15], 0
    v_exp_f32 v54, v54
    v_exp_f32 v55, v55
    v_exp_f32 v56, v56
    v_exp_f32 v57, v57
    v_exp_f32 v58, v58
    v_smfmac_f32_32x32x32_bf16 v[80:95], v[24:27], v[48:55], v9
    ds_read_b128 v[24:27], v5 offset:19008
    v_exp_f32 v59, v59
    v_exp_f32 v60, v60
    v_exp_f32 v61, v61
    v_exp_f32 v62, v62
    v_exp_f32 v63, v63
    s_waitcnt vmcnt(0)
    v_cmp_ne_u32 vcc, s4, v113
    s_and_b64 vcc, vcc, s[100:101]
    s_cbranch_vccnz L_ck_15
L_ckok_16:
    v_cmp_ne_u32 vcc, s64, v112
    s_and_b32 s32, vcc_hi, s101
    s_cselect_b32 s65, 1073741824, 0
    s_barrier
    v_exp_f32 v32, v32
    v_exp_f32 v33, v33
    v_smfmac_f32_32x32x32_bf16 v[80:95], v[28:31], v[56:63], v9
    ds_read_b128 v[28:31], v6 offset:19008
    v_exp_f32 v34, v34
    s_add_u32 s92, s87, s86
    v_exp_f32 v35, v35
    buffer_load_dwordx4 a[0:3], v2, s[8:11], s92 offen offset:0 sc1
    s_add_u32 s87, s87, 4096
    s_and_b32 s87, s87, 32767
    v_exp_f32 v36, v36
    v_exp_f32 v37, v37
    v_mfma_f32_32x32x16_bf16 v[48:63], v[20:23], v[16:19], 0
    ds_read_b128 v[20:23], v4 offset:19456
    v_exp_f32 v38, v38
    v_exp_f32 v39, v39
    v_exp_f32 v40, v40
    v_exp_f32 v41, v41
    v_exp_f32 v42, v42
    s_waitcnt lgkmcnt(2)
    v_smfmac_f32_32x32x32_bf16 v[64:79], v[24:27], v[32:39], v9
    v_exp_f32 v43, v43
    s_add_u32 m0, s39, s45
    v_exp_f32 v44, v44
    buffer_load_dwordx4 v2, s[8:11], s38 offen offset:2048 sc1 lds
    s_add_u32 s39, s39, s48
    s_add_u32 s38, s38, 4096
    v_exp_f32 v45, v45
    v_exp_f32 v46, v46
    v_exp_f32 v47, v47
    v_exp_f32 v48, v48
    v_exp_f32 v49, v49
    s_waitcnt lgkmcnt(0)
    v_smfmac_f32_32x32x32_bf16 v[64:79], v[28:31], v[40:47], v9
    v_exp_f32 v50, v50
    v_exp_f32 v51, v51
    buffer_load_dwordx4 a[4:7], v2, s[8:11], s92 offen offset:1024 sc1
    v_exp_f32 v52, v52
    v_exp_f32 v53, v53
    v_mfma_f32_32x32x16_bf16 v[32:47], v[20:23], v[12:15], 0
    v_exp_f32 v54, v54
    v_exp_f32 v55, v55
    v_exp_f32 v56, v56
    v_exp_f32 v57, v57
    v_exp_f32 v58, v58
    v_smfmac_f32_32x32x32_bf16 v[80:95], v[24:27], v[48:55], v9
    ds_read_b128 v[24:27], v5 offset:20064
    v_exp_f32 v59, v59
    v_exp_f32 v60, v60
    v_exp_f32 v61, v61
    v_exp_f32 v62, v62
    v_exp_f32 v63, v63
    v_exp_f32 v32, v32
    v_exp_f32 v33, v33
    v_smfmac_f32_32x32x32_bf16 v[80:95], v[28:31], v[56:63], v9
    ds_read_b128 v[28:31], v6 offset:20064
    v_exp_f32 v34, v34
    v_exp_f32 v35, v35
    buffer_load_dwordx4 a[8:11], v2, s[8:11], s92 offen offset:2048 sc1
    v_exp_f32 v36, v36
    v_exp_f32 v37, v37
    v_mfma_f32_32x32x16_bf16 v[48:63], v[20:23], v[16:19], 0
    ds_read_b128 v[20:23], v4 offset:20480
    v_exp_f32 v38, v38
    v_exp_f32 v39, v39
    v_exp_f32 v40, v40
    v_exp_f32 v41, v41
    v_exp_f32 v42, v42
    s_waitcnt lgkmcnt(2)
    v_smfmac_f32_32x32x32_bf16 v[64:79], v[24:27], v[32:39], v9
    v_exp_f32 v43, v43
    v_exp_f32 v44, v44
    v_exp_f32 v45, v45
    v_exp_f32 v46, v46
    v_exp_f32 v47, v47
    v_exp_f32 v48, v48
    v_exp_f32 v49, v49
    s_waitcnt lgkmcnt(0)
    v_smfmac_f32_32x32x32_bf16 v[64:79], v[28:31], v[40:47], v9
    v_exp_f32 v50, v50
    v_exp_f32 v51, v51
    buffer_load_dwordx4 a[12:15], v2, s[8:11], s92 offen offset:3072 sc1
    v_exp_f32 v52, v52
    v_exp_f32 v53, v53
    v_mfma_f32_32x32x16_bf16 v[32:47], v[20:23], v[12:15], 0
    v_exp_f32 v54, v54
    v_exp_f32 v55, v55
    v_exp_f32 v56, v56
    v_exp_f32 v57, v57
    v_exp_f32 v58, v58
    v_smfmac_f32_32x32x32_bf16 v[80:95], v[24:27], v[48:55], v9
    ds_read_b128 v[24:27], v5 offset:21120
    v_exp_f32 v59, v59
    v_exp_f32 v60, v60
    v_exp_f32 v61, v61
    v_exp_f32 v62, v62
    v_exp_f32 v63, v63
    s_waitcnt vmcnt(6)
    s_barrier
    v_exp_f32 v32, v32
    v_exp_f32 v33, v33
    v_smfmac_f32_32x32x32_bf16 v[80:95], v[28:31], v[56:63], v9
    ds_read_b128 v[28:31], v6 offset:21120
    v_exp_f32 v34, v34
    v_exp_f32 v35, v35
    buffer_load_dwordx4 v[116:119], v2, s[8:11], s85 offen sc1
    v_exp_f32 v36, v36
    v_exp_f32 v37, v37
    v_mfma_f32_32x32x16_bf16 v[48:63], v[20:23], v[16:19], 0
    ds_read_b128 v[20:23], v4 offset:21504
    v_exp_f32 v38, v38
    v_exp_f32 v39, v39
    v_exp_f32 v40, v40
    v_exp_f32 v41, v41
    v_exp_f32 v42, v42
    s_waitcnt lgkmcnt(2)
    v_smfmac_f32_32x32x32_bf16 v[64:79], v[24:27], v[32:39], v9
    v_exp_f32 v43, v43
    s_mov_b32 m0, s39
    v_exp_f32 v44, v44
    buffer_load_dwordx4 v2, s[8:11], s38 offen sc1 lds
    v_exp_f32 v45, v45
    v_exp_f32 v46, v46
    v_exp_f32 v47, v47
    v_exp_f32 v48, v48
    v_exp_f32 v49, v49
    s_waitcnt lgkmcnt(0)
    v_smfmac_f32_32x32x32_bf16 v[64:79], v[28:31], v[40:47], v9
    v_exp_f32 v50, v50
    s_add_u32 s92, s87, s86
    v_exp_f32 v51, v51
    buffer_load_dwordx4 a[16:19], v2, s[8:11], s92 offen offset:0 sc1
    s_add_u32 s87, s87, 4096
    s_and_b32 s87, s87, 32767
    v_exp_f32 v52, v52
    v_exp_f32 v53, v53
    v_mfma_f32_32x32x16_bf16 v[32:47], v[20:23], v[12:15], 0
    v_exp_f32 v54, v54
    v_exp_f32 v55, v55
    v_exp_f32 v56, v56
    v_exp_f32 v57, v57
    v_exp_f32 v58, v58
    v_smfmac_f32_32x32x32_bf16 v[80:95], v[24:27], v[48:55], v9
    ds_read_b128 v[24:27], v5 offset:22176
    v_exp_f32 v59, v59
    v_exp_f32 v60, v60
    v_exp_f32 v61, v61
    v_exp_f32 v62, v62
    v_exp_f32 v63, v63
    v_exp_f32 v32, v32
    v_exp_f32 v33, v33
    v_smfmac_f32_32x32x32_bf16 v[80:95], v[28:31], v[56:63], v9
    ds_read_b128 v[28:31], v6 offset:22176
    v_exp_f32 v34, v34
    v_exp_f32 v35, v35
    v_exp_f32 v36, v36
    v_exp_f32 v37, v37
    v_mfma_f32_32x32x16_bf16 v[48:63], v[20:23], v[16:19], 0
    ds_read_b128 v[20:23], v4 offset:22528
    v_exp_f32 v38, v38
    v_exp_f32 v39, v39
    v_exp_f32 v40, v40
    v_exp_f32 v41, v41
    v_exp_f32 v42, v42
    s_waitcnt lgkmcnt(2)
    v_smfmac_f32_32x32x32_bf16 v[64:79], v[24:27], v[32:39], v9
    v_exp_f32 v43, v43
    v_exp_f32 v44, v44
    buffer_load_dwordx4 a[20:23], v2, s[8:11], s92 offen offset:1024 sc1
    v_exp_f32 v45, v45
    v_exp_f32 v46, v46
    v_exp_f32 v47, v47
    v_exp_f32 v48, v48
    v_exp_f32 v49, v49
    s_waitcnt lgkmcnt(0)
    v_smfmac_f32_32x32x32_bf16 v[64:79], v[28:31], v[40:47], v9
    v_exp_f32 v50, v50
    v_exp_f32 v51, v51
    buffer_load_dwordx4 v[120:123], v2, s[8:11], s85 offen offset:1024 sc1
    v_exp_f32 v52, v52
    v_exp_f32 v53, v53
    v_mfma_f32_32x32x16_bf16 v[32:47], v[20:23], v[12:15], 0
    v_exp_f32 v54, v54
    v_exp_f32 v55, v55
    v_exp_f32 v56, v56
    v_exp_f32 v57, v57
    v_exp_f32 v58, v58
    v_smfmac_f32_32x32x32_bf16 v[80:95], v[24:27], v[48:55], v9
    ds_read_b128 v[24:27], v5 offset:23232
    v_exp_f32 v59, v59
    v_exp_f32 v60, v60
    buffer_load_dwordx4 a[24:27], v2, s[8:11], s92 offen offset:2048 sc1
    v_exp_f32 v61, v61
    v_exp_f32 v62, v62
    v_exp_f32 v63, v63
    s_waitcnt vmcnt(9)
    v_exp_f32 v32, v32
    v_exp_f32 v33, v33
    v_smfmac_f32_32x32x32_bf16 v[80:95], v[28:31], v[56:63], v9
    ds_read_b128 v[28:31], v6 offset:23232
    v_exp_f32 v34, v34
    v_exp_f32 v35, v35
    buffer_load_dwordx4 a[28:31], v2, s[8:11], s92 offen offset:3072 sc1
    v_exp_f32 v36, v36
    v_exp_f32 v37, v37
    v_mfma_f32_32x32x16_bf16 v[48:63], v[20:23], v[16:19], 0
    ds_read_b128 v[20:23], v4 offset:23552
    v_exp_f32 v38, v38
    v_exp_f32 v39, v39
    v_exp_f32 v40, v40
    v_exp_f32 v41, v41
    v_exp_f32 v42, v42
    s_waitcnt lgkmcnt(2)
    v_smfmac_f32_32x32x32_bf16 v[64:79], v[24:27], v[32:39], v9
    v_exp_f32 v43, v43
    s_add_u32 m0, s39, s45
    v_exp_f32 v44, v44
    buffer_load_dwordx4 v2, s[8:11], s38 offen offset:2048 sc1 lds
    s_add_u32 s39, s39, s48
    s_add_u32 s38, s38, 4096
    v_exp_f32 v45, v45
    v_exp_f32 v46, v46
    v_exp_f32 v47, v47
    v_exp_f32 v48, v48
    v_exp_f32 v49, v49
    s_waitcnt lgkmcnt(0)
    v_smfmac_f32_32x32x32_bf16 v[64:79], v[28:31], v[40:47], v9
    v_exp_f32 v50, v50
    s_add_u32 s92, s87, s86
    v_exp_f32 v51, v51
    buffer_load_dwordx4 a[32:35], v2, s[8:11], s92 offen offset:0 sc1
    s_add_u32 s87, s87, 4096
    s_and_b32 s87, s87, 32767
    v_exp_f32 v52, v52
    v_exp_f32 v53, v53
    v_mfma_f32_32x32x16_bf16 v[32:47], v[20:23], v[12:15], 0
    v_exp_f32 v54, v54
    v_exp_f32 v55, v55
    v_exp_f32 v56, v56
    v_exp_f32 v57, v57
    v_exp_f32 v58, v58
    v_smfmac_f32_32x32x32_bf16 v[80:95], v[24:27], v[48:55], v9
    ds_read_b128 v[24:27], v5 offset:24288
    v_exp_f32 v59, v59
    v_exp_f32 v60, v60
    v_exp_f32 v61, v61
    v_exp_f32 v62, v62
    v_exp_f32 v63, v63
    v_exp_f32 v32, v32
    v_exp_f32 v33, v33
    v_smfmac_f32_32x32x32_bf16 v[80:95], v[28:31], v[56:63], v9
    ds_read_b128 v[28:31], v6 offset:24288
    v_exp_f32 v34, v34
    v_exp_f32 v35, v35
    buffer_load_dwordx4 a[36:39], v2, s[8:11], s92 offen offset:1024 sc1
    v_exp_f32 v36, v36
    v_exp_f32 v37, v37
    v_mfma_f32_32x32x16_bf16 v[48:63], v[20:23], v[16:19], 0
    ds_read_b128 v[20:23], v4 offset:24576
    v_exp_f32 v38, v38
    v_exp_f32 v39, v39
    v_exp_f32 v40, v40
    v_exp_f32 v41, v41
    v_exp_f32 v42, v42
    s_waitcnt lgkmcnt(2)
    v_smfmac_f32_32x32x32_bf16 v[64:79], v[24:27], v[32:39], v9
    v_exp_f32 v43, v43
    s_add_u32 s79, s78, s67
    s_add_u32 m0, s80, 0
    v_exp_f32 v44, v44
    buffer_load_dwordx4 v2, s[8:11], s79 offen sc1 lds
    v_exp_f32 v45, v45
    v_exp_f32 v46, v46
    v_exp_f32 v47, v47
    v_exp_f32 v48, v48
    v_exp_f32 v49, v49
    s_waitcnt lgkmcnt(0)
    v_smfmac_f32_32x32x32_bf16 v[64:79], v[28:31], v[40:47], v9
    v_exp_f32 v50, v50
    v_exp_f32 v51, v51
    buffer_load_dword v124, v106, s[8:11], s97 offen offset:0
    v_exp_f32 v52, v52
    v_exp_f32 v53, v53
    v_mfma_f32_32x32x16_bf16 v[32:47], v[20:23], v[12:15], 0
    v_exp_f32 v54, v54
    v_exp_f32 v55, v55
    v_exp_f32 v56, v56
    v_exp_f32 v57, v57
    v_exp_f32 v58, v58
    v_smfmac_f32_32x32x32_bf16 v[80:95], v[24:27], v[48:55], v9
    ds_read_b128 v[24:27], v5 offset:25344
    v_exp_f32 v59, v59
    v_exp_f32 v60, v60
    buffer_load_dwordx4 a[40:43], v2, s[8:11], s92 offen offset:2048 sc1
    v_exp_f32 v61, v61
    v_exp_f32 v62, v62
    v_exp_f32 v63, v63
    s_waitcnt vmcnt(11)
    s_barrier
    v_exp_f32 v32, v32
    v_exp_f32 v33, v33
    v_smfmac_f32_32x32x32_bf16 v[80:95], v[28:31], v[56:63], v9
    ds_read_b128 v[28:31], v6 offset:25344
    v_exp_f32 v34, v34
    v_exp_f32 v35, v35
    buffer_load_dwordx4 a[44:47], v2, s[8:11], s92 offen offset:3072 sc1
    v_exp_f32 v36, v36
    v_exp_f32 v37, v37
    v_mfma_f32_32x32x16_bf16 v[48:63], v[20:23], v[16:19], 0
    ds_read_b128 v[20:23], v4 offset:25600
    v_exp_f32 v38, v38
    v_exp_f32 v39, v39
    v_exp_f32 v40, v40
    v_exp_f32 v41, v41
    v_exp_f32 v42, v42
    s_waitcnt lgkmcnt(2)
    v_smfmac_f32_32x32x32_bf16 v[64:79], v[24:27], v[32:39], v9
    v_exp_f32 v43, v43
    s_add_u32 s92, s87, s86
    v_exp_f32 v44, v44
    buffer_load_dwordx4 a[48:51], v2, s[8:11], s92 offen offset:0 sc1
    s_add_u32 s87, s87, 4096
    s_and_b32 s87, s87, 32767
    v_exp_f32 v45, v45
    v_exp_f32 v46, v46
    v_exp_f32 v47, v47
    v_exp_f32 v48, v48
    v_exp_f32 v49, v49
    s_waitcnt lgkmcnt(0)
    v_smfmac_f32_32x32x32_bf16 v[64:79], v[28:31], v[40:47], v9
    v_exp_f32 v50, v50
    v_exp_f32 v51, v51
    v_exp_f32 v52, v52
    v_exp_f32 v53, v53
    v_mfma_f32_32x32x16_bf16 v[32:47], v[20:23], v[12:15], 0
    v_exp_f32 v54, v54
    v_exp_f32 v55, v55
    v_exp_f32 v56, v56
    v_exp_f32 v57, v57
    v_exp_f32 v58, v58
    v_smfmac_f32_32x32x32_bf16 v[80:95], v[24:27], v[48:55], v9
    ds_read_b128 v[24:27], v5 offset:26400
    v_exp_f32 v59, v59
    v_exp_f32 v60, v60
    buffer_load_dword v124, v106, s[8:11], s97 offen offset:1024
    v_exp_f32 v61, v61
    v_exp_f32 v62, v62
    v_exp_f32 v63, v63
    v_exp_f32 v32, v32
    v_exp_f32 v33, v33
    v_smfmac_f32_32x32x32_bf16 v[80:95], v[28:31], v[56:63], v9
    ds_read_b128 v[28:31], v6 offset:26400
    v_exp_f32 v34, v34
    s_add_u32 m0, s80, 0
    v_exp_f32 v35, v35
    buffer_load_dwordx4 v2, s[8:11], s79 offen offset:2048 sc1 lds
    s_add_u32 s78, s78, 4096
    s_and_b32 s78, s78, 16383
    v_exp_f32 v36, v36
    v_exp_f32 v37, v37
    v_mfma_f32_32x32x16_bf16 v[48:63], v[20:23], v[16:19], 0
    ds_read_b128 v[20:23], v4 offset:26624
    v_exp_f32 v38, v38
    v_exp_f32 v39, v39
    v_exp_f32 v40, v40
    v_exp_f32 v41, v41
    v_exp_f32 v42, v42
    s_waitcnt lgkmcnt(2)
    v_smfmac_f32_32x32x32_bf16 v[64:79], v[24:27], v[32:39], v9
    v_exp_f32 v43, v43
    v_exp_f32 v44, v44
    buffer_load_dwordx4 a[52:55], v2, s[8:11], s92 offen offset:1024 sc1
    v_exp_f32 v45, v45
    v_exp_f32 v46, v46
    v_exp_f32 v47, v47
    v_exp_f32 v48, v48
    v_exp_f32 v49, v49
    s_waitcnt lgkmcnt(0)
    v_smfmac_f32_32x32x32_bf16 v[64:79], v[28:31], v[40:47], v9
    v_exp_f32 v50, v50
    v_exp_f32 v51, v51
    buffer_load_dwordx4 a[56:59], v2, s[8:11], s92 offen offset:2048 sc1
    v_exp_f32 v52, v52
    v_exp_f32 v53, v53
    v_mfma_f32_32x32x16_bf16 v[32:47], v[20:23], v[12:15], 0
    v_exp_f32 v54, v54
    v_exp_f32 v55, v55
    v_exp_f32 v56, v56
    v_exp_f32 v57, v57
    v_exp_f32 v58, v58
    v_smfmac_f32_32x32x32_bf16 v[80:95], v[24:27], v[48:55], v9
    ds_read_b128 v[24:27], v5 offset:27456
    v_exp_f32 v59, v59
    v_exp_f32 v60, v60
    buffer_load_dword v124, v106, s[8:11], s97 offen offset:2048
    v_exp_f32 v61, v61
    v_exp_f32 v62, v62
    v_exp_f32 v63, v63
    s_waitcnt vmcnt(12)
    v_exp_f32 v32, v32
    v_exp_f32 v33, v33
    v_smfmac_f32_32x32x32_bf16 v[80:95], v[28:31], v[56:63], v9
    ds_read_b128 v[28:31], v6 offset:27456
    v_exp_f32 v34, v34
    v_exp_f32 v35, v35
    v_exp_f32 v36, v36
    v_exp_f32 v37, v37
    v_mfma_f32_32x32x16_bf16 v[48:63], v[20:23], v[16:19], 0
    ds_read_b128 v[20:23], v4 offset:27648
    v_exp_f32 v38, v38
    v_exp_f32 v39, v39
    v_exp_f32 v40, v40
    v_exp_f32 v41, v41
    v_exp_f32 v42, v42
    s_waitcnt lgkmcnt(2)
    v_smfmac_f32_32x32x32_bf16 v[64:79], v[24:27], v[32:39], v9
    v_exp_f32 v43, v43
    v_exp_f32 v44, v44
    buffer_load_dwordx4 a[60:63], v2, s[8:11], s92 offen offset:3072 sc1
    v_exp_f32 v45, v45
    v_exp_f32 v46, v46
    v_exp_f32 v47, v47
    v_exp_f32 v48, v48
    v_exp_f32 v49, v49
    s_waitcnt lgkmcnt(0)
    v_smfmac_f32_32x32x32_bf16 v[64:79], v[28:31], v[40:47], v9
    v_exp_f32 v50, v50
    v_exp_f32 v51, v51
    buffer_load_dwordx4 v[96:99], v107, s[12:15], s96 offen
    v_exp_f32 v52, v52
    v_exp_f32 v53, v53
    v_mfma_f32_32x32x16_bf16 v[32:47], v[20:23], v[12:15], 0
    v_exp_f32 v54, v54
    v_exp_f32 v55, v55
    v_exp_f32 v56, v56
    v_exp_f32 v57, v57
    v_exp_f32 v58, v58
    v_smfmac_f32_32x32x32_bf16 v[80:95], v[24:27], v[48:55], v9
    ds_read_b128 v[24:27], v5 offset:28512
    v_exp_f32 v59, v59
    s_add_u32 s79, s78, s67
    s_add_u32 m0, s80, 4096
    v_exp_f32 v60, v60
    buffer_load_dwordx4 v2, s[8:11], s79 offen sc1 lds
    v_exp_f32 v61, v61
    v_exp_f32 v62, v62
    v_exp_f32 v63, v63
    v_exp_f32 v32, v32
    v_exp_f32 v33, v33
    v_smfmac_f32_32x32x32_bf16 v[80:95], v[28:31], v[56:63], v9
    ds_read_b128 v[28:31], v6 offset:28512
    v_exp_f32 v34, v34
    v_exp_f32 v35, v35
    buffer_load_dword v124, v106, s[8:11], s97 offen offset:3072
    s_add_u32 s97, s97, 4096
    v_exp_f32 v36, v36
    v_exp_f32 v37, v37
    v_mfma_f32_32x32x16_bf16 v[48:63], v[20:23], v[16:19], 0
    ds_read_b128 v[20:23], v4 offset:28672
    v_exp_f32 v38, v38
    v_exp_f32 v39, v39
    v_exp_f32 v40, v40
    v_exp_f32 v41, v41
    v_exp_f32 v42, v42
    s_waitcnt lgkmcnt(2)
    v_smfmac_f32_32x32x32_bf16 v[64:79], v[24:27], v[32:39], v9
    v_exp_f32 v43, v43
    s_add_u32 s92, s87, s86
    v_exp_f32 v44, v44
    buffer_load_dwordx4 a[64:67], v2, s[8:11], s92 offen offset:0 sc1
    s_add_u32 s87, s87, 4096
    s_and_b32 s87, s87, 32767
    v_exp_f32 v45, v45
    v_exp_f32 v46, v46
    v_exp_f32 v47, v47
    v_exp_f32 v48, v48
    v_exp_f32 v49, v49
    s_waitcnt lgkmcnt(0)
    v_smfmac_f32_32x32x32_bf16 v[64:79], v[28:31], v[40:47], v9
    v_exp_f32 v50, v50
    v_exp_f32 v51, v51
    buffer_load_dwordx4 a[68:71], v2, s[8:11], s92 offen offset:1024 sc1
    v_exp_f32 v52, v52
    v_exp_f32 v53, v53
    v_mfma_f32_32x32x16_bf16 v[32:47], v[20:23], v[12:15], 0
    v_exp_f32 v54, v54
    v_exp_f32 v55, v55
    v_exp_f32 v56, v56
    v_exp_f32 v57, v57
    v_exp_f32 v58, v58
    v_smfmac_f32_32x32x32_bf16 v[80:95], v[24:27], v[48:55], v9
    ds_read_b128 v[24:27], v5 offset:29568
    v_exp_f32 v59, v59
    v_exp_f32 v60, v60
    v_exp_f32 v61, v61
    v_exp_f32 v62, v62
    v_exp_f32 v63, v63
    s_waitcnt vmcnt(18)
    s_barrier
    v_exp_f32 v32, v32
    v_exp_f32 v33, v33
    v_smfmac_f32_32x32x32_bf16 v[80:95], v[28:31], v[56:63], v9
    ds_read_b128 v[28:31], v6 offset:29568
    v_exp_f32 v34, v34
    v_exp_f32 v35, v35
    buffer_load_dwordx4 a[72:75], v2, s[8:11], s92 offen offset:2048 sc1
    v_exp_f32 v36, v36
    v_exp_f32 v37, v37
    v_mfma_f32_32x32x16_bf16 v[48:63], v[20:23], v[16:19], 0
    ds_read_b128 v[20:23], v4 offset:29696
    v_exp_f32 v38, v38
    v_exp_f32 v39, v39
    v_exp_f32 v40, v40
    v_exp_f32 v41, v41
    v_exp_f32 v42, v42
    s_waitcnt lgkmcnt(2)
    v_smfmac_f32_32x32x32_bf16 v[64:79], v[24:27], v[32:39], v9
    v_exp_f32 v43, v43
    v_exp_f32 v44, v44
    buffer_load_dword v124, v106, s[8:11], s97 offen offset:0
    v_exp_f32 v45, v45
    v_exp_f32 v46, v46
    v_exp_f32 v47, v47
    v_exp_f32 v48, v48
    v_exp_f32 v49, v49
    s_waitcnt lgkmcnt(0)
    v_smfmac_f32_32x32x32_bf16 v[64:79], v[28:31], v[40:47], v9
    v_exp_f32 v50, v50
    s_add_u32 m0, s80, 4096
    v_exp_f32 v51, v51
    buffer_load_dwordx4 v2, s[8:11], s79 offen offset:2048 sc1 lds
    s_add_u32 s78, s78, 4096
    s_and_b32 s78, s78, 16383
    v_exp_f32 v52, v52
    v_exp_f32 v53, v53
    v_mfma_f32_32x32x16_bf16 v[32:47], v[20:23], v[12:15], 0
    v_exp_f32 v54, v54
    v_exp_f32 v55, v55
    v_exp_f32 v56, v56
    v_exp_f32 v57, v57
    v_exp_f32 v58, v58
    v_smfmac_f32_32x32x32_bf16 v[80:95], v[24:27], v[48:55], v9
    ds_read_b128 v[24:27], v5 offset:30624
    v_exp_f32 v59, v59
    v_exp_f32 v60, v60
    buffer_load_dwordx4 a[76:79], v2, s[8:11], s92 offen offset:3072 sc1
    v_exp_f32 v61, v61
    v_exp_f32 v62, v62
    v_exp_f32 v63, v63
    v_exp_f32 v32, v32
    v_exp_f32 v33, v33
    v_smfmac_f32_32x32x32_bf16 v[80:95], v[28:31], v[56:63], v9
    ds_read_b128 v[28:31], v6 offset:30624
    v_exp_f32 v34, v34
    s_add_u32 s79, s78, s67
    s_add_u32 m0, s80, 8192
    v_exp_f32 v35, v35
    buffer_load_dwordx4 v2, s[8:11], s79 offen sc1 lds
    v_exp_f32 v36, v36
    v_exp_f32 v37, v37
    v_mfma_f32_32x32x16_bf16 v[48:63], v[20:23], v[16:19], 0
    ds_read_b128 v[20:23], v4 offset:30720
    v_exp_f32 v38, v38
    v_exp_f32 v39, v39
    v_exp_f32 v40, v40
    v_exp_f32 v41, v41
    v_exp_f32 v42, v42
    s_waitcnt lgkmcnt(2)
    v_smfmac_f32_32x32x32_bf16 v[64:79], v[24:27], v[32:39], v9
    v_exp_f32 v43, v43
    v_exp_f32 v44, v44
    v_exp_f32 v45, v45
    v_exp_f32 v46, v46
    v_exp_f32 v47, v47
    v_exp_f32 v48, v48
    v_exp_f32 v49, v49
    s_waitcnt lgkmcnt(0)
    v_smfmac_f32_32x32x32_bf16 v[64:79], v[28:31], v[40:47], v9
    v_exp_f32 v50, v50
    v_exp_f32 v51, v51
    buffer_load_dword v124, v106, s[8:11], s97 offen offset:1024
    v_exp_f32 v52, v52
    v_exp_f32 v53, v53
    v_mfma_f32_32x32x16_bf16 v[32:47], v[20:23], v[12:15], 0
    v_exp_f32 v54, v54
    v_exp_f32 v55, v55
    v_exp_f32 v56, v56
    v_exp_f32 v57, v57
    v_exp_f32 v58, v58
    v_smfmac_f32_32x32x32_bf16 v[80:95], v[24:27], v[48:55], v9
    ds_read_b128 v[24:27], v5 offset:31680
    v_exp_f32 v59, v59
    s_add_u32 m0, s80, 8192
    v_exp_f32 v60, v60
    buffer_load_dwordx4 v2, s[8:11], s79 offen offset:2048 sc1 lds
    s_add_u32 s78, s78, 4096
    s_and_b32 s78, s78, 16383
    v_exp_f32 v61, v61
    v_exp_f32 v62, v62
    v_exp_f32 v63, v63
    v_exp_f32 v32, v32
    v_exp_f32 v33, v33
    v_smfmac_f32_32x32x32_bf16 v[80:95], v[28:31], v[56:63], v9
    ds_read_b128 v[28:31], v6 offset:31680
    v_exp_f32 v34, v34
    s_add_u32 s79, s78, s67
    s_add_u32 m0, s80, 12288
    v_exp_f32 v35, v35
    buffer_load_dwordx4 v2, s[8:11], s79 offen sc1 lds
    v_exp_f32 v36, v36
    v_exp_f32 v37, v37
    v_mfma_f32_32x32x16_bf16 v[48:63], v[20:23], v[16:19], 0
    ds_read_b128 v[20:23], v4 offset:31744
    v_exp_f32 v38, v38
    v_exp_f32 v39, v39
    v_exp_f32 v40, v40
    v_exp_f32 v41, v41
    v_exp_f32 v42, v42
    s_waitcnt lgkmcnt(2)
    v_smfmac_f32_32x32x32_bf16 v[64:79], v[24:27], v[32:39], v9
    v_exp_f32 v43, v43
    s_add_u32 m0, s80, 12288
    v_exp_f32 v44, v44
    buffer_load_dwordx4 v2, s[8:11], s79 offen offset:2048 sc1 lds
    s_add_u32 s78, s78, 4096
    s_and_b32 s78, s78, 16383
    v_exp_f32 v45, v45
    v_exp_f32 v46, v46
    v_exp_f32 v47, v47
    v_exp_f32 v48, v48
    v_exp_f32 v49, v49
    s_waitcnt lgkmcnt(0)
    v_smfmac_f32_32x32x32_bf16 v[64:79], v[28:31], v[40:47], v9
    v_exp_f32 v50, v50
    v_exp_f32 v51, v51
    buffer_load_dword v124, v106, s[8:11], s97 offen offset:2048
    v_exp_f32 v52, v52
    v_exp_f32 v53, v53
    v_mfma_f32_32x32x16_bf16 v[32:47], v[20:23], v[12:15], 0
    v_exp_f32 v54, v54
    v_exp_f32 v55, v55
    v_exp_f32 v56, v56
    v_exp_f32 v57, v57
    v_exp_f32 v58, v58
    v_smfmac_f32_32x32x32_bf16 v[80:95], v[24:27], v[48:55], v9
    ds_read_b128 v[24:27], v5 offset:32736
    v_exp_f32 v59, v59
    v_exp_f32 v60, v60
    v_exp_f32 v61, v61
    v_exp_f32 v62, v62
    v_exp_f32 v63, v63
    v_exp_f32 v32, v32
    v_exp_f32 v33, v33
    v_smfmac_f32_32x32x32_bf16 v[80:95], v[28:31], v[56:63], v9
    ds_read_b128 v[28:31], v6 offset:32736
    v_exp_f32 v34, v34
    v_exp_f32 v35, v35
    v_exp_f32 v36, v36
    v_exp_f32 v37, v37
    v_mfma_f32_32x32x16_bf16 v[48:63], v[20:23], v[16:19], 0
    ds_read_b128 v[20:23], v4 offset:32768
    v_exp_f32 v38, v38
    v_exp_f32 v39, v39
    v_exp_f32 v40, v40
    v_exp_f32 v41, v41
    v_exp_f32 v42, v42
    s_waitcnt lgkmcnt(2)
    v_smfmac_f32_32x32x32_bf16 v[64:79], v[24:27], v[32:39], v9
    v_exp_f32 v43, v43
    v_exp_f32 v44, v44
    v_exp_f32 v45, v45
    v_exp_f32 v46, v46
    v_exp_f32 v47, v47
    v_exp_f32 v48, v48
    v_exp_f32 v49, v49
    s_waitcnt lgkmcnt(0)
    v_smfmac_f32_32x32x32_bf16 v[64:79], v[28:31], v[40:47], v9
    v_exp_f32 v50, v50
    v_exp_f32 v51, v51
    v_exp_f32 v52, v52
    v_exp_f32 v53, v53
    v_mfma_f32_32x32x16_bf16 v[32:47], v[20:23], v[12:15], 0
    v_exp_f32 v54, v54
    v_exp_f32 v55, v55
    v_exp_f32 v56, v56
    v_exp_f32 v57, v57
    v_exp_f32 v58, v58
    v_smfmac_f32_32x32x32_bf16 v[80:95], v[24:27], v[48:55], v9
    ds_read_b128 v[24:27], v5 offset:33792
    v_exp_f32 v59, v59
    v_exp_f32 v60, v60
    v_exp_f32 v61, v61
    v_exp_f32 v62, v62
    v_exp_f32 v63, v63
L_att1:
    s_mul_i32 s32, s3, 2304
    s_add_u32 s32, s32, 133120
    v_smfmac_f32_32x32x32_bf16 v[80:95], v[28:31], v[56:63], v9
    v_add_u32 v5, s32, v2
    v_add_u32 v10, s32, v3
    s_xor_b32 s33, s3, 4
    s_mul_i32 s33, s33, 2304
    s_add_u32 s33, s33, 133120
    v_add_u32 v11, s33, v2
    v_add_u32 v4, s33, v3
    s_lshl_b32 s32, s58, 5
    s_add_u32 s32, s32, s76
    s_lshl_b32 s32, s32, 10
    s_add_u32 s42, s32, 9437184
    s_nop 0
    ds_write_b128 v5, v[80:83]
    ds_write_b128 v5, v[84:87] offset:1024
    ds_write_b32 v10, v88 offset:2048
    s_waitcnt vmcnt(1) lgkmcnt(0)
    s_barrier
    ds_read_b128 v[48:51], v11
    ds_read_b128 v[52:55], v11 offset:1024
    ds_read_b32 v56, v4 offset:2048
    s_mov_b32 s32, 0x71800000
    s_mov_b32 s33, 0x7e800000
    s_waitcnt lgkmcnt(0)
    v_pk_add_f32 v[64:65], v[64:65], v[48:49]
    v_pk_add_f32 v[66:67], v[66:67], v[50:51]
    v_pk_add_f32 v[68:69], v[68:69], v[52:53]
    v_pk_add_f32 v[70:71], v[70:71], v[54:55]
    v_add_f32 v72, v72, v56
    v_add_f32 v10, abs(v64), abs(v65)
    v_add_f32 v10, v10, abs(v66)
    v_add_f32 v10, v10, abs(v67)
    v_add_f32 v10, v10, abs(v68)
    v_add_f32 v10, v10, abs(v69)
    v_add_f32 v10, v10, abs(v70)
    v_add_f32 v10, v10, abs(v71)
    v_cmp_nle_f32 vcc, 0x1f800000, v72
    v_cmp_nge_f32 s[40:41], s32, v72
    s_or_b64 vcc, vcc, s[40:41]
    v_cmp_nge_f32 s[40:41], s33, v10
    s_or_b64 vcc, vcc, s[40:41]
    s_cbranch_vccnz L_fallback
L_fb_ret:
    v_rcp_f32 v10, v72
    v_rcp_f32 v11, v72
    s_nop 0
    v_pk_mul_f32 v[64:65], v[64:65], v[10:11]
    v_pk_mul_f32 v[66:67], v[66:67], v[10:11]
    v_pk_mul_f32 v[68:69], v[68:69], v[10:11]
    v_pk_mul_f32 v[70:71], v[70:71], v[10:11]
    v_cvt_pk_bf16_f32 v48, v64, v65
    v_cvt_pk_bf16_f32 v49, v66, v67
    v_cvt_pk_bf16_f32 v50, v68, v69
    v_cvt_pk_bf16_f32 v51, v70, v71
    buffer_store_dwordx4 v[48:51], v2, s[8:11], s42 offen sc1
    s_lshl_b32 s32, s56, 16
    s_add_u32 s42, s98, s32
    s_add_u32 s42, s42, 9437184
    s_mov_b32 s44, s49
    s_bitcmp1_b32 s99, 0
    s_mov_b32 s34, 16384
    s_mov_b32 s35, 82432
    s_cselect_b32 s34, 49152, s34
    s_cselect_b32 s35, 116224, s35
    s_bitcmp1_b32 s99, 1
    s_cselect_b32 s39, s35, s34
    s_lshl_b32 s32, s37, 10
    s_add_u32 s39, s39, s32
    s_lshl_b32 s45, s77, 5
    s_add_u32 s45, s45, s76
    s_lshl_b32 s45, s45, 7
    s_add_u32 s45, s45, 131072
    s_lshr_b32 s48, s56, 2
    s_lshl_b32 s48, s48, 12
    s_add_u32 s48, s48, 131072
    s_waitcnt vmcnt(1)
    v_pk_add_f32 v[116:117], v[116:117], v[120:121]
    v_pk_add_f32 v[118:119], v[118:119], v[122:123]
    s_nop 1
    v_permlane32_swap_b32 v116, v117
    v_permlane32_swap_b32 v118, v119
    v_add_f32 v116, v116, v117
    v_add_f32 v118, v118, v119
    s_nop 1
    v_permlane16_swap_b32 v116, v118
    v_add_f32 v116, v116, v118
    v_and_b32 v10, 15, v1
    v_lshrrev_b32 v11, 4, v1
    v_lshlrev_b32 v10, 4, v10
    v_lshl_add_u32 v10, v11, 9, v10
    s_bitcmp1_b32 s3, 1
    s_cselect_b32 s32, 65536, 0
    s_cselect_b32 s33, 66560, 0
    s_add_u32 s33, s33, 32768
    s_lshl_b32 s34, s37, 8
    s_add_u32 s32, s32, s34
    s_add_u32 s33, s33, s34
    v_add_u32 v4, s32, v10
    v_add_u32 v5, s33, v10
    s_bitcmp1_b32 s3, 0
    s_cselect_b32 s32, 66048, 0
    s_cselect_b32 s33, 67072, 0
    s_add_u32 s32, s32, 16384
    s_add_u32 s33, s33, 49152
    v_add_u32 v6, s32, v10
    v_add_u32 v8, s33, v10
    s_lshl_b32 s32, s3, 8
    s_add_u32 s32, s32, 153600
    v_add_u32 v10, s32, v3
    v_lshrrev_b32 v11, 1, v7
    v_add_u32 v11, s32, v11
    ds_write_b32 v10, v112
    ds_read_b64 v[100:101], v11 offset:64
    ds_read_b64 v[102:103], v11 offset:80
    ds_read_b64 v[104:105], v11 offset:96
    ds_read_b64 v[106:107], v11 offset:112
    ds_read_b128 v[12:15], v4 offset:0
    ds_read_b128 v[16:19], v5 offset:0
    ds_read_b128 v[20:23], v4 offset:2048
    ds_read_b128 v[24:27], v5 offset:2048
    ds_read_b128 v[28:31], v4 offset:4096
    ds_read_b128 v[32:35], v5 offset:4096
    ds_read_b128 v[36:39], v4 offset:6144
    ds_read_b128 v[40:43], v5 offset:6144
    v_permlane32_swap_b32 v96, v98
    v_permlane32_swap_b32 v97, v99
    s_add_u32 s36, s47, 11534336
    s_lshr_b32 s43, s47, 2
    s_add_u32 s43, s43, 458752
    v_lshlrev_b32 v84, 16, v96
    v_and_b32 v85, 0xffff0000, v96
    v_lshlrev_b32 v86, 16, v97
    v_and_b32 v87, 0xffff0000, v97
    v_lshlrev_b32 v88, 16, v98
    v_and_b32 v89, 0xffff0000, v98
    v_lshlrev_b32 v90, 16, v99
    v_and_b32 v91, 0xffff0000, v99
    s_waitcnt lgkmcnt(8)
    v_lshlrev_b32 v118, 16, v100
    v_and_b32 v119, 0xffff0000, v100
    v_lshlrev_b32 v120, 16, v101
    v_and_b32 v121, 0xffff0000, v101
    v_lshlrev_b32 v122, 16, v102
    v_and_b32 v123, 0xffff0000, v102
    v_lshlrev_b32 v124, 16, v103
    v_and_b32 v125, 0xffff0000, v103
    s_waitcnt vmcnt(0)
    s_barrier
    s_cmp_lg_u32 s3, 0
    s_cbranch_scc1 L_p3_a
    v_mov_b32 v10, s4
    buffer_store_dword v10, v0, s[8:11], s45 offen sc1
L_p3_a:
    s_add_u32 s92, s87, s86
    buffer_load_dwordx4 a[80:83], v2, s[8:11], s92 offen offset:0 sc1
    s_add_u32 s87, s87, 4096
    s_and_b32 s87, s87, 32767
    buffer_load_dwordx4 a[84:87], v2, s[8:11], s92 offen offset:1024 sc1
    buffer_load_dwordx4 a[88:91], v2, s[8:11], s92 offen offset:2048 sc1
    buffer_load_dwordx4 a[92:95], v2, s[8:11], s92 offen offset:3072 sc1
    s_add_u32 s92, s87, s86
    buffer_load_dwordx4 a[96:99], v2, s[8:11], s92 offen offset:0 sc1
    s_add_u32 s87, s87, 4096
    s_and_b32 s87, s87, 32767
    buffer_load_dwordx4 a[100:103], v2, s[8:11], s92 offen offset:1024 sc1
    buffer_load_dwordx4 a[104:107], v2, s[8:11], s92 offen offset:2048 sc1
    buffer_load_dwordx4 a[108:111], v2, s[8:11], s92 offen offset:3072 sc1
    s_add_u32 s92, s87, s86
    buffer_load_dwordx4 a[112:115], v2, s[8:11], s92 offen offset:0 sc1
    s_add_u32 s87, s87, 4096
    s_and_b32 s87, s87, 32767
    buffer_load_dwordx4 a[116:119], v2, s[8:11], s92 offen offset:1024 sc1
    buffer_load_dwordx4 a[120:123], v2, s[8:11], s92 offen offset:2048 sc1
    buffer_load_dwordx4 a[124:127], v2, s[8:11], s92 offen offset:3072 sc1
    s_cmp_lg_u32 s3, 0
    s_cbranch_scc1 L_p3_b
    s_mov_b32 exec_lo, 0xffffffff
    s_mov_b32 exec_hi, 0x0
    s_mov_b32 s33, 0
L_poll_17:
    buffer_load_dword v10, v126, s[8:11], s48 offen sc1
    s_waitcnt vmcnt(0)
    v_cmp_ne_u32 vcc, s4, v10
    s_cbranch_vccz L_got_18
    s_add_u32 s33, s33, 1
    s_cmp_lt_u32 s33, 100000
    s_cbranch_scc1 L_poll_17
L_got_18:
    s_mov_b64 exec, -1
L_p3_b:
    s_barrier
    s_add_u32 s32, s44, s42
    s_add_u32 m0, s39, 0
    s_add_u32 s44, s44, 2048
    buffer_load_dwordx4 v2, s[8:11], s32 offen sc1 lds
    s_and_b32 s44, s44, 16383
    s_barrier
    s_add_u32 s32, s44, s42
    s_add_u32 m0, s39, 2048
    s_add_u32 s44, s44, 2048
    buffer_load_dwordx4 v2, s[8:11], s32 offen sc1 lds
    s_and_b32 s44, s44, 16383
    s_barrier
    s_add_u32 s32, s44, s42
    s_add_u32 m0, s39, 4096
    s_add_u32 s44, s44, 2048
    buffer_load_dwordx4 v2, s[8:11], s32 offen sc1 lds
    s_and_b32 s44, s44, 16383
    s_barrier
    s_add_u32 s32, s44, s42
    s_add_u32 m0, s39, 6144
    s_add_u32 s44, s44, 2048
    buffer_load_dwordx4 v2, s[8:11], s32 offen sc1 lds
    s_and_b32 s44, s44, 16383
    s_waitcnt vmcnt(3)
    s_barrier
    ds_read_b128 v[44:47], v6 offset:0
    ds_read_b128 v[48:51], v6 offset:256
    ds_read_b128 v[52:55], v8 offset:0
    ds_read_b128 v[56:59], v8 offset:256
    s_add_u32 s32, s44, s42
    s_add_u32 m0, s39, 8192
    s_add_u32 s44, s44, 2048
    buffer_load_dwordx4 v2, s[8:11], s32 offen sc1 lds
    s_and_b32 s44, s44, 16383
    s_waitcnt vmcnt(3)
    s_barrier
    ds_read_b128 v[60:63], v6 offset:2048
    ds_read_b128 v[64:67], v6 offset:2304
    ds_read_b128 v[68:71], v8 offset:2048
    ds_read_b128 v[72:75], v8 offset:2304
    s_add_u32 s32, s44, s42
    s_add_u32 m0, s39, 10240
    s_add_u32 s44, s44, 2048
    buffer_load_dwordx4 v2, s[8:11], s32 offen sc1 lds
    s_and_b32 s44, s44, 16383
    s_waitcnt lgkmcnt(4)
    v_mfma_f32_16x16x32_bf16 v[76:79], v[12:15], v[44:47], 0
    v_mfma_f32_16x16x32_bf16 v[80:83], v[12:15], v[48:51], 0
    v_mfma_f32_16x16x32_bf16 v[76:79], v[16:19], v[52:55], v[76:79]
    v_mfma_f32_16x16x32_bf16 v[80:83], v[16:19], v[56:59], v[80:83]
    ds_read_b128 v[12:15], v4 offset:8192
    ds_read_b128 v[16:19], v5 offset:8192
    s_waitcnt vmcnt(3)
    s_barrier
    ds_read_b128 v[44:47], v6 offset:4096
    ds_read_b128 v[48:51], v6 offset:4352
    ds_read_b128 v[52:55], v8 offset:4096
    ds_read_b128 v[56:59], v8 offset:4352
    s_add_u32 s32, s44, s42
    s_add_u32 m0, s39, 12288
    s_add_u32 s44, s44, 2048
    buffer_load_dwordx4 v2, s[8:11], s32 offen sc1 lds
    s_and_b32 s44, s44, 16383
    s_waitcnt lgkmcnt(4)
    v_mfma_f32_16x16x32_bf16 v[76:79], v[20:23], v[60:63], v[76:79]
    v_mfma_f32_16x16x32_bf16 v[80:83], v[20:23], v[64:67], v[80:83]
    v_mfma_f32_16x16x32_bf16 v[76:79], v[24:27], v[68:71], v[76:79]
    v_mfma_f32_16x16x32_bf16 v[80:83], v[24:27], v[72:75], v[80:83]
    ds_read_b128 v[20:23], v4 offset:10240
    ds_read_b128 v[24:27], v5 offset:10240
    s_waitcnt vmcnt(3)
    s_barrier
    ds_read_b128 v[60:63], v6 offset:6144
    ds_read_b128 v[64:67], v6 offset:6400
    ds_read_b128 v[68:71], v8 offset:6144
    ds_read_b128 v[72:75], v8 offset:6400
    s_add_u32 s32, s44, s42
    s_add_u32 m0, s39, 14336
    s_add_u32 s44, s44, 2048
    buffer_load_dwordx4 v2, s[8:11], s32 offen sc1 lds
    s_and_b32 s44, s44, 16383
    s_waitcnt lgkmcnt(4)
    v_mfma_f32_16x16x32_bf16 v[76:79], v[28:31], v[44:47], v[76:79]
    v_mfma_f32_16x16x32_bf16 v[80:83], v[28:31], v[48:51], v[80:83]
    v_mfma_f32_16x16x32_bf16 v[76:79], v[32:35], v[52:55], v[76:79]
    v_mfma_f32_16x16x32_bf16 v[80:83], v[32:35], v[56:59], v[80:83]
    ds_read_b128 v[28:31], v4 offset:12288
    ds_read_b128 v[32:35], v5 offset:12288
    s_waitcnt vmcnt(3)
    s_barrier
    ds_read_b128 v[44:47], v6 offset:8192
    ds_read_b128 v[48:51], v6 offset:8448
    ds_read_b128 v[52:55], v8 offset:8192
    ds_read_b128 v[56:59], v8 offset:8448
    s_waitcnt lgkmcnt(4)
    v_mfma_f32_16x16x32_bf16 v[76:79], v[36:39], v[60:63], v[76:79]
    v_mfma_f32_16x16x32_bf16 v[80:83], v[36:39], v[64:67], v[80:83]
    v_mfma_f32_16x16x32_bf16 v[76:79], v[40:43], v[68:71], v[76:79]
    v_mfma_f32_16x16x32_bf16 v[80:83], v[40:43], v[72:75], v[80:83]
    ds_read_b128 v[36:39], v4 offset:14336
    ds_read_b128 v[40:43], v5 offset:14336
    s_waitcnt vmcnt(2)
    s_barrier
    ds_read_b128 v[60:63], v6 offset:10240
    ds_read_b128 v[64:67], v6 offset:10496
    ds_read_b128 v[68:71], v8 offset:10240
    ds_read_b128 v[72:75], v8 offset:10496
    s_waitcnt lgkmcnt(4)
    v_mfma_f32_16x16x32_bf16 v[76:79], v[12:15], v[44:47], v[76:79]
    v_mfma_f32_16x16x32_bf16 v[80:83], v[12:15], v[48:51], v[80:83]
    v_mfma_f32_16x16x32_bf16 v[76:79], v[16:19], v[52:55], v[76:79]
    v_mfma_f32_16x16x32_bf16 v[80:83], v[16:19], v[56:59], v[80:83]
    s_waitcnt vmcnt(1)
    s_barrier
    ds_read_b128 v[44:47], v6 offset:12288
    ds_read_b128 v[48:51], v6 offset:12544
    ds_read_b128 v[52:55], v8 offset:12288
    ds_read_b128 v[56:59], v8 offset:12544
    s_waitcnt lgkmcnt(4)
    v_mfma_f32_16x16x32_bf16 v[76:79], v[20:23], v[60:63], v[76:79]
    v_mfma_f32_16x16x32_bf16 v[80:83], v[20:23], v[64:67], v[80:83]
    v_mfma_f32_16x16x32_bf16 v[76:79], v[24:27], v[68:71], v[76:79]
    v_mfma_f32_16x16x32_bf16 v[80:83], v[24:27], v[72:75], v[80:83]
    s_waitcnt vmcnt(0)
    s_barrier
    ds_read_b128 v[60:63], v6 offset:14336
    ds_read_b128 v[64:67], v6 offset:14592
    ds_read_b128 v[68:71], v8 offset:14336
    ds_read_b128 v[72:75], v8 offset:14592
    s_waitcnt lgkmcnt(4)
    v_mfma_f32_16x16x32_bf16 v[76:79], v[28:31], v[44:47], v[76:79]
    v_mfma_f32_16x16x32_bf16 v[80:83], v[28:31], v[48:51], v[80:83]
    v_mfma_f32_16x16x32_bf16 v[76:79], v[32:35], v[52:55], v[76:79]
    v_mfma_f32_16x16x32_bf16 v[80:83], v[32:35], v[56:59], v[80:83]
    s_waitcnt lgkmcnt(3)
    v_mfma_f32_16x16x32_bf16 v[76:79], v[36:39], v[60:63], v[76:79]
    s_waitcnt lgkmcnt(2)
    v_mfma_f32_16x16x32_bf16 v[80:83], v[36:39], v[64:67], v[80:83]
    s_waitcnt lgkmcnt(1)
    v_mfma_f32_16x16x32_bf16 v[76:79], v[40:43], v[68:71], v[76:79]
    s_waitcnt lgkmcnt(0)
    v_mfma_f32_16x16x32_bf16 v[80:83], v[40:43], v[72:75], v[80:83]
    s_mov_b32 s42, s36
    s_mov_b32 s44, s43
    s_nop 5
    v_permlane16_swap_b32 v76, v80
    v_permlane16_swap_b32 v77, v81
    v_permlane16_swap_b32 v78, v82
    v_permlane16_swap_b32 v79, v83
    v_permlane32_swap_b32 v76, v80
    v_permlane32_swap_b32 v77, v81
    v_permlane32_swap_b32 v78, v82
    v_permlane32_swap_b32 v79, v83
    v_pk_fma_f32 v[76:77], v[76:77], v[118:119], v[84:85]
    v_pk_fma_f32 v[78:79], v[78:79], v[120:121], v[86:87]
    v_pk_fma_f32 v[80:81], v[80:81], v[122:123], v[88:89]
    v_pk_fma_f32 v[82:83], v[82:83], v[124:125], v[90:91]
    v_cvt_pk_bf16_f32 v96, v76, v77
    v_cvt_pk_bf16_f32 v97, v78, v79
    v_cvt_pk_bf16_f32 v98, v80, v81
    v_cvt_pk_bf16_f32 v99, v82, v83
    s_xor_b32 s66, s65, 1073741824
    buffer_store_dwordx4 v[96:99], v2, s[8:11], s42 offen offset:0 sc1
    v_pk_add_f32 v[12:13], v[76:77], v[78:79]
    v_pk_mul_f32 v[14:15], v[76:77], v[76:77]
    v_pk_add_f32 v[16:17], v[80:81], v[82:83]
    v_pk_fma_f32 v[14:15], v[78:79], v[78:79], v[14:15]
    v_pk_add_f32 v[12:13], v[12:13], v[16:17]
    v_pk_fma_f32 v[14:15], v[80:81], v[80:81], v[14:15]
    v_add_f32 v12, v12, v13
    v_pk_fma_f32 v[14:15], v[82:83], v[82:83], v[14:15]
    v_add_f32 v14, v14, v15
    s_nop 1
    v_permlane32_swap_b32 v12, v14
    v_add_f32 v12, v12, v14
    buffer_store_dword v12, v3, s[8:11], s44 offen offset:0 sc1
    s_and_b32 s32, s3, 1
    s_lshr_b32 s33, s3, 1
    s_lshl_b32 s39, s32, 5
    s_add_u32 s39, s39, s33
    s_lshl_b32 s39, s39, 10
    s_lshl_b32 s38, s59, 5
    s_add_u32 s38, s38, s33
    s_lshl_b32 s38, s38, 10
    s_add_u32 s38, s38, 11534336
    s_lshl_b32 s45, s56, 1
    s_lshl_b32 s45, s45, 12
    s_and_b32 s45, s45, 32767
    s_lshl_b32 s48, s56, 10
    s_lshl_b32 s43, s57, 7
    s_add_u32 s43, s43, s48
    s_add_u32 s48, s48, 163840
    s_add_u32 s49, s43, 163840
    s_lshl_b32 s32, s3, 8
    s_add_u32 s32, s32, 153600
    v_and_b32 v4, 15, v1
    v_cmp_lt_u32 vcc, 7, v4
    v_lshl_add_u32 v4, v4, 4, s32
    v_bfe_u32 v10, v1, 4, 1
    v_lshl_add_u32 v4, v10, 3, v4
    v_lshrrev_b32 v10, 5, v1
    v_lshl_add_u32 v4, v10, 2, v4
    v_add_u32 v5, s32, v7
    v_mul_f32 v10, 0xbfb8aa3b, v116
    v_cndmask_b32 v10, v116, v10, vcc
    ds_write_b32 v4, v10
    s_lshr_b32 s33, s60, 1
    s_mul_i32 s46, s33, 114688
    s_mul_i32 s33, s61, 28672
    s_add_u32 s46, s46, s33
    s_add_u32 s46, s46, 15990784
    s_add_u32 s44, s46, s62
    s_add_u32 s36, s46, 28672
    s_mul_i32 s92, s56, 229376
    s_add_u32 s92, s92, 17825792
    s_lshl_b32 s32, s63, 11
    s_add_u32 s42, s92, s32
    s_add_u32 s47, s42, 114688
    s_mov_b32 s90, 1.0
    s_mov_b32 s91, 1.0
    v_and_b32 v10, 31, v1
    v_lshlrev_b32 v6, 4, v10
    v_add_u32 v6, 65536, v6
    v_lshl_add_u32 v124, v10, 10, v7
    s_lshl_b32 s32, s61, 11
    v_add_u32 v112, s32, v2
    v_add_u32 v113, 49152, v112
    s_and_b32 s33, s3, 2
    s_lshl_b32 s33, s33, 13
    s_add_u32 s33, s33, 98304
    s_add_u32 s32, s32, s33
    v_add_u32 v114, s32, v2
    s_lshl_b32 s32, s37, 13
    s_add_u32 s33, s33, s32
    s_and_b32 s32, s3, 1
    s_lshl_b32 s32, s32, 15
    s_add_u32 s33, s33, s32
    v_add_u32 v115, s33, v2
    s_waitcnt lgkmcnt(0)
    ds_read_b128 v[64:67], v5 offset:0
    ds_read_b128 v[80:83], v5 offset:128
    ds_read_b128 v[68:71], v5 offset:32
    ds_read_b128 v[84:87], v5 offset:160
    ds_read_b128 v[72:75], v5 offset:64
    ds_read_b128 v[88:91], v5 offset:192
    ds_read_b128 v[76:79], v5 offset:96
    ds_read_b128 v[92:95], v5 offset:224
    s_waitcnt vmcnt(0)
    s_barrier
    s_cmp_lg_u32 s3, 0
    s_cbranch_scc1 L_p4_a
    s_cmp_eq_u32 s65, 0
    s_cselect_b32 s32, 29229056, 0
    s_add_u32 s48, s48, s32
    s_add_u32 s32, s49, 29229056
    s_add_u32 s32, s32, s65
    s_xor_b32 s33, s65, 1073741824
    s_add_u32 s49, s49, s33
    v_mov_b32 v10, s4
    buffer_store_dword v10, v0, s[8:11], s32 offen
    buffer_store_dword v10, v0, s[8:11], s49 offen sc1
L_p4_a:
    s_cmp_lg_u32 s3, 0
    s_cbranch_scc1 L_p4_b
    s_mov_b32 exec_lo, 0xff
    s_mov_b32 exec_hi, 0x0
    s_mov_b32 s33, 0
L_poll_19:
    buffer_load_dword v10, v126, s[8:11], s48 offen sc1
    s_waitcnt vmcnt(0)
    v_cmp_ne_u32 vcc, s4, v10
    s_cbranch_vccz L_got_20
    s_add_u32 s33, s33, 1
    s_cmp_lt_u32 s33, 100000
    s_cbranch_scc1 L_poll_19
L_got_20:
    s_mov_b64 exec, -1
L_p4_b:
    s_barrier
    s_add_u32 s32, s45, s38
    s_add_u32 m0, s39, 0
    s_add_u32 s45, s45, 4096
    buffer_load_dwordx4 v2, s[8:11], s32 offen sc1 lds
    s_and_b32 s45, s45, 32767
    s_barrier
    s_add_u32 s32, s45, s38
    s_add_u32 m0, s39, 4096
    s_add_u32 s45, s45, 4096
    buffer_load_dwordx4 v2, s[8:11], s32 offen sc1 lds
    s_and_b32 s45, s45, 32767
    s_barrier
    s_add_u32 s32, s45, s38
    s_add_u32 m0, s39, 8192
    s_add_u32 s45, s45, 4096
    buffer_load_dwordx4 v2, s[8:11], s32 offen sc1 lds
    s_and_b32 s45, s45, 32767
    s_barrier
    s_add_u32 s32, s45, s38
    s_add_u32 m0, s39, 12288
    s_add_u32 s45, s45, 4096
    buffer_load_dwordx4 v2, s[8:11], s32 offen sc1 lds
    s_and_b32 s45, s45, 32767
    s_cmp_eq_u32 s3, 7
    s_cbranch_scc1 L_p4_stat
    s_waitcnt vmcnt(3)
    s_barrier
    ds_read_b128 v[12:15], v2 offset:0
    ds_read_b128 v[16:19], v2 offset:32768
    ds_read_b128 v[20:23], v2 offset:1024
    ds_read_b128 v[24:27], v2 offset:33792
    ds_read_b128 v[28:31], v2 offset:2048
    s_waitcnt lgkmcnt(3)
    v_mfma_f32_32x32x16_bf16 v[32:47], a[0:3], v[12:15], 0
    ds_read_b128 v[120:123], v2 offset:34816
    v_mfma_f32_32x32x16_bf16 v[48:63], a[0:3], v[16:19], 0
    ds_read_b128 v[12:15], v2 offset:3072
    s_add_u32 s32, s45, s38
    s_add_u32 m0, s39, 16384
    s_add_u32 s45, s45, 4096
    buffer_load_dwordx4 v2, s[8:11], s32 offen sc1 lds
    s_and_b32 s45, s45, 32767
    s_waitcnt lgkmcnt(3)
    v_mfma_f32_32x32x16_bf16 v[32:47], a[4:7], v[20:23], v[32:47]
    ds_read_b128 v[16:19], v2 offset:35840
    v_mfma_f32_32x32x16_bf16 v[48:63], a[4:7], v[24:27], v[48:63]
    s_add_u32 s32, s45, s38
    s_add_u32 m0, s39, 20480
    s_add_u32 s45, s45, 4096
    buffer_load_dwordx4 v2, s[8:11], s32 offen sc1 lds
    s_and_b32 s45, s45, 32767
    s_waitcnt lgkmcnt(2)
    v_mfma_f32_32x32x16_bf16 v[32:47], a[8:11], v[28:31], v[32:47]
    v_mfma_f32_32x32x16_bf16 v[48:63], a[8:11], v[120:123], v[48:63]
    s_add_u32 s32, s45, s38
    s_add_u32 m0, s39, 24576
    s_add_u32 s45, s45, 4096
    buffer_load_dwordx4 v2, s[8:11], s32 offen sc1 lds
    s_and_b32 s45, s45, 32767
    s_waitcnt lgkmcnt(0)
    v_mfma_f32_32x32x16_bf16 v[32:47], a[12:15], v[12:15], v[32:47]
    v_mfma_f32_32x32x16_bf16 v[48:63], a[12:15], v[16:19], v[48:63]
    s_add_u32 s32, s45, s38
    s_add_u32 m0, s39, 28672
    s_add_u32 s45, s45, 4096
    buffer_load_dwordx4 v2, s[8:11], s32 offen sc1 lds
    s_and_b32 s45, s45, 32767
    s_waitcnt vmcnt(6)
    s_barrier
    ds_read_b128 v[20:23], v2 offset:4096
    ds_read_b128 v[24:27], v2 offset:36864
    ds_read_b128 v[28:31], v2 offset:5120
    ds_read_b128 v[120:123], v2 offset:37888
    ds_read_b128 v[12:15], v2 offset:6144
    s_waitcnt lgkmcnt(3)
    v_mfma_f32_32x32x16_bf16 v[32:47], a[16:19], v[20:23], v[32:47]
    ds_read_b128 v[16:19], v2 offset:38912
    v_mfma_f32_32x32x16_bf16 v[48:63], a[16:19], v[24:27], v[48:63]
    ds_read_b128 v[20:23], v2 offset:7168
    buffer_load_dwordx4 a[0:3], v2, s[8:11], s44 offen offset:0 sc1
    s_waitcnt lgkmcnt(3)
    v_mfma_f32_32x32x16_bf16 v[32:47], a[20:23], v[28:31], v[32:47]
    ds_read_b128 v[24:27], v2 offset:39936
    v_mfma_f32_32x32x16_bf16 v[48:63], a[20:23], v[120:123], v[48:63]
    buffer_load_dwordx4 a[4:7], v2, s[8:11], s44 offen offset:1024 sc1
    s_waitcnt lgkmcnt(2)
    v_mfma_f32_32x32x16_bf16 v[32:47], a[24:27], v[12:15], v[32:47]
    v_mfma_f32_32x32x16_bf16 v[48:63], a[24:27], v[16:19], v[48:63]
    buffer_load_dwordx4 a[8:11], v2, s[8:11], s44 offen offset:2048 sc1
    s_waitcnt lgkmcnt(0)
    v_mfma_f32_32x32x16_bf16 v[32:47], a[28:31], v[20:23], v[32:47]
    v_mfma_f32_32x32x16_bf16 v[48:63], a[28:31], v[24:27], v[48:63]
    buffer_load_dwordx4 a[12:15], v2, s[8:11], s44 offen offset:3072 sc1
    s_add_u32 s44, s44, 4096
    s_cmp_eq_u32 s44, s36
    s_cselect_b32 s44, s46, s44
    s_waitcnt vmcnt(8)
    s_barrier
    ds_read_b128 v[28:31], v2 offset:8192
    ds_read_b128 v[120:123], v2 offset:40960
    ds_read_b128 v[12:15], v2 offset:9216
    ds_read_b128 v[16:19], v2 offset:41984
    ds_read_b128 v[20:23], v2 offset:10240
    s_waitcnt lgkmcnt(3)
    v_mfma_f32_32x32x16_bf16 v[32:47], a[32:35], v[28:31], v[32:47]
    ds_read_b128 v[24:27], v2 offset:43008
    v_mfma_f32_32x32x16_bf16 v[48:63], a[32:35], v[120:123], v[48:63]
    ds_read_b128 v[28:31], v2 offset:11264
    buffer_load_dwordx4 a[16:19], v2, s[8:11], s44 offen offset:0 sc1
    s_waitcnt lgkmcnt(3)
    v_mfma_f32_32x32x16_bf16 v[32:47], a[36:39], v[12:15], v[32:47]
    ds_read_b128 v[120:123], v2 offset:44032
    v_mfma_f32_32x32x16_bf16 v[48:63], a[36:39], v[16:19], v[48:63]
    ds_read_b128 v[12:15], v2 offset:12288
    buffer_load_dwordx4 a[20:23], v2, s[8:11], s44 offen offset:1024 sc1
    s_waitcnt lgkmcnt(3)
    v_mfma_f32_32x32x16_bf16 v[32:47], a[40:43], v[20:23], v[32:47]
    ds_read_b128 v[16:19], v2 offset:45056
    v_mfma_f32_32x32x16_bf16 v[48:63], a[40:43], v[24:27], v[48:63]
    ds_read_b128 v[20:23], v2 offset:13312
    buffer_load_dwordx4 a[24:27], v2, s[8:11], s44 offen offset:2048 sc1
    s_waitcnt lgkmcnt(3)
    v_mfma_f32_32x32x16_bf16 v[32:47], a[44:47], v[28:31], v[32:47]
    ds_read_b128 v[24:27], v2 offset:46080
    v_mfma_f32_32x32x16_bf16 v[48:63], a[44:47], v[120:123], v[48:63]
    ds_read_b128 v[28:31], v2 offset:14336
    buffer_load_dwordx4 a[28:31], v2, s[8:11], s44 offen offset:3072 sc1
    s_add_u32 s44, s44, 4096
    s_cmp_eq_u32 s44, s36
    s_cselect_b32 s44, s46, s44
    s_waitcnt lgkmcnt(3)
    v_mfma_f32_32x32x16_bf16 v[32:47], a[48:51], v[12:15], v[32:47]
    ds_read_b128 v[120:123], v2 offset:47104
    v_mfma_f32_32x32x16_bf16 v[48:63], a[48:51], v[16:19], v[48:63]
    ds_read_b128 v[12:15], v2 offset:15360
    buffer_load_dwordx4 a[32:35], v2, s[8:11], s44 offen offset:0 sc1
    s_waitcnt lgkmcnt(3)
    v_mfma_f32_32x32x16_bf16 v[32:47], a[52:55], v[20:23], v[32:47]
    ds_read_b128 v[16:19], v2 offset:48128
    v_mfma_f32_32x32x16_bf16 v[48:63], a[52:55], v[24:27], v[48:63]
    buffer_load_dwordx4 a[36:39], v2, s[8:11], s44 offen offset:1024 sc1
    s_waitcnt lgkmcnt(2)
    v_mfma_f32_32x32x16_bf16 v[32:47], a[56:59], v[28:31], v[32:47]
    v_mfma_f32_32x32x16_bf16 v[48:63], a[56:59], v[120:123], v[48:63]
    buffer_load_dwordx4 a[40:43], v2, s[8:11], s44 offen offset:2048 sc1
    s_waitcnt lgkmcnt(0)
    v_mfma_f32_32x32x16_bf16 v[32:47], a[60:63], v[12:15], v[32:47]
    v_mfma_f32_32x32x16_bf16 v[48:63], a[60:63], v[16:19], v[48:63]
    buffer_load_dwordx4 a[44:47], v2, s[8:11], s44 offen offset:3072 sc1
    s_add_u32 s44, s44, 4096
    s_cmp_eq_u32 s44, s36
    s_cselect_b32 s44, s46, s44
    s_waitcnt vmcnt(12)
    s_barrier
    ds_read_b128 v[20:23], v2 offset:16384
    ds_read_b128 v[24:27], v2 offset:49152
    ds_read_b128 v[28:31], v2 offset:17408
    ds_read_b128 v[120:123], v2 offset:50176
    ds_read_b128 v[12:15], v2 offset:18432
    s_waitcnt lgkmcnt(3)
    v_mfma_f32_32x32x16_bf16 v[32:47], a[64:67], v[20:23], v[32:47]
    ds_read_b128 v[16:19], v2 offset:51200
    v_mfma_f32_32x32x16_bf16 v[48:63], a[64:67], v[24:27], v[48:63]
    ds_read_b128 v[20:23], v2 offset:19456
    buffer_load_dwordx4 a[48:51], v2, s[8:11], s44 offen offset:0 sc1
    s_waitcnt lgkmcnt(3)
    v_mfma_f32_32x32x16_bf16 v[32:47], a[68:71], v[28:31], v[32:47]
    ds_read_b128 v[24:27], v2 offset:52224
    v_mfma_f32_32x32x16_bf16 v[48:63], a[68:71], v[120:123], v[48:63]
    ds_read_b128 v[28:31], v2 offset:20480
    buffer_load_dwordx4 a[52:55], v2, s[8:11], s44 offen offset:1024 sc1
    s_waitcnt lgkmcnt(3)
    v_mfma_f32_32x32x16_bf16 v[32:47], a[72:75], v[12:15], v[32:47]
    ds_read_b128 v[120:123], v2 offset:53248
    v_mfma_f32_32x32x16_bf16 v[48:63], a[72:75], v[16:19], v[48:63]
    ds_read_b128 v[12:15], v2 offset:21504
    buffer_load_dwordx4 a[56:59], v2, s[8:11], s44 offen offset:2048 sc1
    s_waitcnt lgkmcnt(3)
    v_mfma_f32_32x32x16_bf16 v[32:47], a[76:79], v[20:23], v[32:47]
    ds_read_b128 v[16:19], v2 offset:54272
    v_mfma_f32_32x32x16_bf16 v[48:63], a[76:79], v[24:27], v[48:63]
    ds_read_b128 v[20:23], v2 offset:22528
    buffer_load_dwordx4 a[60:63], v2, s[8:11], s44 offen offset:3072 sc1
    s_add_u32 s44, s44, 4096
    s_cmp_eq_u32 s44, s36
    s_cselect_b32 s44, s46, s44
    s_waitcnt lgkmcnt(3)
    v_mfma_f32_32x32x16_bf16 v[32:47], a[80:83], v[28:31], v[32:47]
    ds_read_b128 v[24:27], v2 offset:55296
    v_mfma_f32_32x32x16_bf16 v[48:63], a[80:83], v[120:123], v[48:63]
    ds_read_b128 v[28:31], v2 offset:23552
    buffer_load_dwordx4 a[64:67], v2, s[8:11], s44 offen offset:0 sc1
    s_waitcnt lgkmcnt(3)
    v_mfma_f32_32x32x16_bf16 v[32:47], a[84:87], v[12:15], v[32:47]
    ds_read_b128 v[120:123], v2 offset:56320
    v_mfma_f32_32x32x16_bf16 v[48:63], a[84:87], v[16:19], v[48:63]
    ds_read_b128 v[12:15], v2 offset:24576
    buffer_load_dwordx4 a[68:71], v2, s[8:11], s44 offen offset:1024 sc1
    s_waitcnt lgkmcnt(3)
    v_mfma_f32_32x32x16_bf16 v[32:47], a[88:91], v[20:23], v[32:47]
    ds_read_b128 v[16:19], v2 offset:57344
    v_mfma_f32_32x32x16_bf16 v[48:63], a[88:91], v[24:27], v[48:63]
    ds_read_b128 v[20:23], v2 offset:25600
    buffer_load_dwordx4 a[72:75], v2, s[8:11], s44 offen offset:2048 sc1
    s_waitcnt lgkmcnt(3)
    v_mfma_f32_32x32x16_bf16 v[32:47], a[92:95], v[28:31], v[32:47]
    ds_read_b128 v[24:27], v2 offset:58368
    v_mfma_f32_32x32x16_bf16 v[48:63], a[92:95], v[120:123], v[48:63]
    ds_read_b128 v[28:31], v2 offset:26624
    buffer_load_dwordx4 a[76:79], v2, s[8:11], s44 offen offset:3072 sc1
    s_add_u32 s44, s44, 4096
    s_cmp_eq_u32 s44, s36
    s_cselect_b32 s44, s46, s44
    s_waitcnt lgkmcnt(3)
    v_mfma_f32_32x32x16_bf16 v[32:47], a[96:99], v[12:15], v[32:47]
    ds_read_b128 v[120:123], v2 offset:59392
    v_mfma_f32_32x32x16_bf16 v[48:63], a[96:99], v[16:19], v[48:63]
    ds_read_b128 v[12:15], v2 offset:27648
    buffer_load_dwordx4 a[80:83], v2, s[8:11], s44 offen offset:0 sc1
    s_waitcnt lgkmcnt(3)
    v_mfma_f32_32x32x16_bf16 v[32:47], a[100:103], v[20:23], v[32:47]
    ds_read_b128 v[16:19], v2 offset:60416
    v_mfma_f32_32x32x16_bf16 v[48:63], a[100:103], v[24:27], v[48:63]
    ds_read_b128 v[20:23], v2 offset:28672
    buffer_load_dwordx4 a[84:87], v2, s[8:11], s44 offen offset:1024 sc1
    s_waitcnt lgkmcnt(3)
    v_mfma_f32_32x32x16_bf16 v[32:47], a[104:107], v[28:31], v[32:47]
    ds_read_b128 v[24:27], v2 offset:61440
    v_mfma_f32_32x32x16_bf16 v[48:63], a[104:107], v[120:123], v[48:63]
    ds_read_b128 v[28:31], v2 offset:29696
    buffer_load_dwordx4 a[88:91], v2, s[8:11], s44 offen offset:2048 sc1
    s_waitcnt lgkmcnt(3)
    v_mfma_f32_32x32x16_bf16 v[32:47], a[108:111], v[12:15], v[32:47]
    ds_read_b128 v[120:123], v2 offset:62464
    v_mfma_f32_32x32x16_bf16 v[48:63], a[108:111], v[16:19], v[48:63]
    ds_read_b128 v[12:15], v2 offset:30720
    buffer_load_dwordx4 a[92:95], v2, s[8:11], s44 offen offset:3072 sc1
    s_add_u32 s44, s44, 4096
    s_cmp_eq_u32 s44, s36
    s_cselect_b32 s44, s46, s44
    s_waitcnt lgkmcnt(3)
    v_mfma_f32_32x32x16_bf16 v[32:47], a[112:115], v[20:23], v[32:47]
    ds_read_b128 v[16:19], v2 offset:63488
    v_mfma_f32_32x32x16_bf16 v[48:63], a[112:115], v[24:27], v[48:63]
    ds_read_b128 v[20:23], v2 offset:31744
    buffer_load_dwordx4 a[96:99], v2, s[8:11], s44 offen offset:0 sc1
    s_waitcnt lgkmcnt(3)
    v_mfma_f32_32x32x16_bf16 v[32:47], a[116:119], v[28:31], v[32:47]
    ds_read_b128 v[24:27], v2 offset:64512
    v_mfma_f32_32x32x16_bf16 v[48:63], a[116:119], v[120:123], v[48:63]
    buffer_load_dwordx4 a[100:103], v2, s[8:11], s44 offen offset:1024 sc1
    s_waitcnt lgkmcnt(2)
    v_mfma_f32_32x32x16_bf16 v[32:47], a[120:123], v[12:15], v[32:47]
    v_mfma_f32_32x32x16_bf16 v[48:63], a[120:123], v[16:19], v[48:63]
    buffer_load_dwordx4 a[104:107], v2, s[8:11], s44 offen offset:2048 sc1
    s_waitcnt lgkmcnt(0)
    v_mfma_f32_32x32x16_bf16 v[32:47], a[124:127], v[20:23], v[32:47]
    v_mfma_f32_32x32x16_bf16 v[48:63], a[124:127], v[24:27], v[48:63]
    buffer_load_dwordx4 a[108:111], v2, s[8:11], s44 offen offset:3072 sc1
    s_add_u32 s44, s44, 4096
    s_cmp_eq_u32 s44, s36
    s_cselect_b32 s44, s46, s44
    s_or_b32 s32, s2, s3
    s_cmp_lg_u32 s32, 0
    s_cbranch_scc1 L_noep_21
    s_mov_b32 s32, 0
    v_mov_b32 v10, s4
    s_mov_b64 exec, 1
    buffer_store_dword v10, v3, s[8:11], s32 offen sc1
    s_mov_b64 exec, -1
L_noep_21:
    v_mov_b32 v11, 163784
    s_mov_b32 s33, 0
L_spin_22:
    ds_read_b32 v10, v11
    s_add_u32 s33, s33, 1
    s_waitcnt lgkmcnt(0)
    v_readfirstlane_b32 s32, v10
    s_cmp_ge_u32 s32, 1
    s_cbranch_scc1 L_spun_23
    s_cmp_lt_u32 s33, 400000
    s_cbranch_scc1 L_spin_22
L_spun_23:
    ds_read_b128 v[120:123], v6
    s_waitcnt lgkmcnt(0)
    v_pk_fma_f32 v[116:117], v[64:65], v[120:121], v[80:81]
    v_pk_fma_f32 v[118:119], v[66:67], v[120:121], v[82:83]
    v_pk_fma_f32 v[32:33], v[32:33], v[122:123], v[116:117]
    v_pk_fma_f32 v[34:35], v[34:35], v[122:123], v[118:119]
    v_exp_f32 v116, v32
    v_exp_f32 v117, v33
    v_exp_f32 v118, v34
    v_exp_f32 v119, v35
    v_pk_add_f32 v[116:117], s[90:91], v[116:117]
    v_pk_add_f32 v[118:119], s[90:91], v[118:119]
    v_rcp_f32 v116, v116
    v_rcp_f32 v117, v117
    v_rcp_f32 v118, v118
    v_rcp_f32 v119, v119
    v_pk_mul_f32 v[32:33], v[32:33], v[116:117]
    v_pk_mul_f32 v[34:35], v[34:35], v[118:119]
    v_cvt_pk_bf16_f32 v24, v32, v33
    v_cvt_pk_bf16_f32 v25, v34, v35
    v_pk_fma_f32 v[116:117], v[68:69], v[120:121], v[84:85]
    v_pk_fma_f32 v[118:119], v[70:71], v[120:121], v[86:87]
    v_pk_fma_f32 v[36:37], v[36:37], v[122:123], v[116:117]
    v_pk_fma_f32 v[38:39], v[38:39], v[122:123], v[118:119]
    v_exp_f32 v116, v36
    v_exp_f32 v117, v37
    v_exp_f32 v118, v38
    v_exp_f32 v119, v39
    v_pk_add_f32 v[116:117], s[90:91], v[116:117]
    v_pk_add_f32 v[118:119], s[90:91], v[118:119]
    v_rcp_f32 v116, v116
    v_rcp_f32 v117, v117
    v_rcp_f32 v118, v118
    v_rcp_f32 v119, v119
    v_pk_mul_f32 v[36:37], v[36:37], v[116:117]
    v_pk_mul_f32 v[38:39], v[38:39], v[118:119]
    v_cvt_pk_bf16_f32 v26, v36, v37
    v_cvt_pk_bf16_f32 v27, v38, v39
    buffer_store_dwordx4 v[24:27], v2, s[8:11], s42 offen offset:0 sc1
    v_pk_fma_f32 v[116:117], v[72:73], v[120:121], v[88:89]
    v_pk_fma_f32 v[118:119], v[74:75], v[120:121], v[90:91]
    v_pk_fma_f32 v[40:41], v[40:41], v[122:123], v[116:117]
    v_pk_fma_f32 v[42:43], v[42:43], v[122:123], v[118:119]
    v_exp_f32 v116, v40
    v_exp_f32 v117, v41
    v_exp_f32 v118, v42
    v_exp_f32 v119, v43
    v_pk_add_f32 v[116:117], s[90:91], v[116:117]
    v_pk_add_f32 v[118:119], s[90:91], v[118:119]
    v_rcp_f32 v116, v116
    v_rcp_f32 v117, v117
    v_rcp_f32 v118, v118
    v_rcp_f32 v119, v119
    v_pk_mul_f32 v[40:41], v[40:41], v[116:117]
    v_pk_mul_f32 v[42:43], v[42:43], v[118:119]
    v_cvt_pk_bf16_f32 v28, v40, v41
    v_cvt_pk_bf16_f32 v29, v42, v43
    v_pk_fma_f32 v[116:117], v[76:77], v[120:121], v[92:93]
    v_pk_fma_f32 v[118:119], v[78:79], v[120:121], v[94:95]
    v_pk_fma_f32 v[44:45], v[44:45], v[122:123], v[116:117]
    v_pk_fma_f32 v[46:47], v[46:47], v[122:123], v[118:119]
    v_exp_f32 v116, v44
    v_exp_f32 v117, v45
    v_exp_f32 v118, v46
    v_exp_f32 v119, v47
    v_pk_add_f32 v[116:117], s[90:91], v[116:117]
    v_pk_add_f32 v[118:119], s[90:91], v[118:119]
    v_rcp_f32 v116, v116
    v_rcp_f32 v117, v117
    v_rcp_f32 v118, v118
    v_rcp_f32 v119, v119
    v_pk_mul_f32 v[44:45], v[44:45], v[116:117]
    v_pk_mul_f32 v[46:47], v[46:47], v[118:119]
    v_cvt_pk_bf16_f32 v30, v44, v45
    v_cvt_pk_bf16_f32 v31, v46, v47
    buffer_store_dwordx4 v[28:31], v2, s[8:11], s42 offen offset:1024 sc1
    v_mov_b32 v11, 163784
    s_mov_b32 s33, 0
L_spin_24:
    ds_read_b32 v10, v11
    s_add_u32 s33, s33, 1
    s_waitcnt lgkmcnt(0)
    v_readfirstlane_b32 s32, v10
    s_cmp_ge_u32 s32, 2
    s_cbranch_scc1 L_spun_25
    s_cmp_lt_u32 s33, 400000
    s_cbranch_scc1 L_spin_24
L_spun_25:
    ds_read_b128 v[108:111], v6 offset:512
    s_waitcnt lgkmcnt(0)
    v_pk_fma_f32 v[116:117], v[64:65], v[108:109], v[80:81]
    v_pk_fma_f32 v[118:119], v[66:67], v[108:109], v[82:83]
    v_pk_fma_f32 v[48:49], v[48:49], v[110:111], v[116:117]
    v_pk_fma_f32 v[50:51], v[50:51], v[110:111], v[118:119]
    v_exp_f32 v116, v48
    v_exp_f32 v117, v49
    v_exp_f32 v118, v50
    v_exp_f32 v119, v51
    v_pk_add_f32 v[116:117], s[90:91], v[116:117]
    v_pk_add_f32 v[118:119], s[90:91], v[118:119]
    v_rcp_f32 v116, v116
    v_rcp_f32 v117, v117
    v_rcp_f32 v118, v118
    v_rcp_f32 v119, v119
    v_pk_mul_f32 v[48:49], v[48:49], v[116:117]
    v_pk_mul_f32 v[50:51], v[50:51], v[118:119]
    v_cvt_pk_bf16_f32 v12, v48, v49
    v_cvt_pk_bf16_f32 v13, v50, v51
    v_pk_fma_f32 v[116:117], v[68:69], v[108:109], v[84:85]
    v_pk_fma_f32 v[118:119], v[70:71], v[108:109], v[86:87]
    v_pk_fma_f32 v[52:53], v[52:53], v[110:111], v[116:117]
    v_pk_fma_f32 v[54:55], v[54:55], v[110:111], v[118:119]
    v_exp_f32 v116, v52
    v_exp_f32 v117, v53
    v_exp_f32 v118, v54
    v_exp_f32 v119, v55
    v_pk_add_f32 v[116:117], s[90:91], v[116:117]
    v_pk_add_f32 v[118:119], s[90:91], v[118:119]
    v_rcp_f32 v116, v116
    v_rcp_f32 v117, v117
    v_rcp_f32 v118, v118
    v_rcp_f32 v119, v119
    v_pk_mul_f32 v[52:53], v[52:53], v[116:117]
    v_pk_mul_f32 v[54:55], v[54:55], v[118:119]
    v_cvt_pk_bf16_f32 v14, v52, v53
    v_cvt_pk_bf16_f32 v15, v54, v55
    buffer_store_dwordx4 v[12:15], v2, s[8:11], s47 offen offset:0 sc1
    v_pk_fma_f32 v[116:117], v[72:73], v[108:109], v[88:89]
    v_pk_fma_f32 v[118:119], v[74:75], v[108:109], v[90:91]
    v_pk_fma_f32 v[56:57], v[56:57], v[110:111], v[116:117]
    v_pk_fma_f32 v[58:59], v[58:59], v[110:111], v[118:119]
    v_exp_f32 v116, v56
    v_exp_f32 v117, v57
    v_exp_f32 v118, v58
    v_exp_f32 v119, v59
    v_pk_add_f32 v[116:117], s[90:91], v[116:117]
    v_pk_add_f32 v[118:119], s[90:91], v[118:119]
    v_rcp_f32 v116, v116
    v_rcp_f32 v117, v117
    v_rcp_f32 v118, v118
    v_rcp_f32 v119, v119
    v_pk_mul_f32 v[56:57], v[56:57], v[116:117]
    v_pk_mul_f32 v[58:59], v[58:59], v[118:119]
    v_cvt_pk_bf16_f32 v16, v56, v57
    v_cvt_pk_bf16_f32 v17, v58, v59
    v_pk_fma_f32 v[116:117], v[76:77], v[108:109], v[92:93]
    v_pk_fma_f32 v[118:119], v[78:79], v[108:109], v[94:95]
    v_pk_fma_f32 v[60:61], v[60:61], v[110:111], v[116:117]
    v_pk_fma_f32 v[62:63], v[62:63], v[110:111], v[118:119]
    v_exp_f32 v116, v60
    v_exp_f32 v117, v61
    v_exp_f32 v118, v62
    v_exp_f32 v119, v63
    v_pk_add_f32 v[116:117], s[90:91], v[116:117]
    v_pk_add_f32 v[118:119], s[90:91], v[118:119]
    v_rcp_f32 v116, v116
    v_rcp_f32 v117, v117
    v_rcp_f32 v118, v118
    v_rcp_f32 v119, v119
    v_pk_mul_f32 v[60:61], v[60:61], v[116:117]
    v_pk_mul_f32 v[62:63], v[62:63], v[118:119]
    v_cvt_pk_bf16_f32 v18, v60, v61
    v_cvt_pk_bf16_f32 v19, v62, v63
    buffer_store_dwordx4 v[16:19], v2, s[8:11], s47 offen offset:1024 sc1
    s_branch L_p4_end
L_p4_stat:
    s_lshl_b32 s33, s56, 14
    s_add_u32 s93, s33, 458752
    s_waitcnt lgkmcnt(0)
    s_waitcnt vmcnt(3)
    s_barrier
    s_add_u32 s32, s45, s38
    s_add_u32 m0, s39, 16384
    s_add_u32 s45, s45, 4096
    buffer_load_dwordx4 v2, s[8:11], s32 offen sc1 lds
    s_and_b32 s45, s45, 32767
    s_add_u32 s32, s45, s38
    s_add_u32 m0, s39, 20480
    s_add_u32 s45, s45, 4096
    buffer_load_dwordx4 v2, s[8:11], s32 offen sc1 lds
    s_and_b32 s45, s45, 32767
    s_add_u32 s32, s45, s38
    s_add_u32 m0, s39, 24576
    s_add_u32 s45, s45, 4096
    buffer_load_dwordx4 v2, s[8:11], s32 offen sc1 lds
    s_and_b32 s45, s45, 32767
    s_add_u32 s32, s45, s38
    s_add_u32 m0, s39, 28672
    s_add_u32 s45, s45, 4096
    buffer_load_dwordx4 v2, s[8:11], s32 offen sc1 lds
    s_and_b32 s45, s45, 32767
    buffer_load_dword v12, v3, s[8:11], s93 offen offset:0 sc1
    buffer_load_dword v13, v3, s[8:11], s93 offen offset:256 sc1
    buffer_load_dword v14, v3, s[8:11], s93 offen offset:512 sc1
    buffer_load_dword v15, v3, s[8:11], s93 offen offset:768 sc1
    buffer_load_dword v16, v3, s[8:11], s93 offen offset:1024 sc1
    buffer_load_dword v17, v3, s[8:11], s93 offen offset:1280 sc1
    buffer_load_dword v18, v3, s[8:11], s93 offen offset:1536 sc1
    buffer_load_dword v19, v3, s[8:11], s93 offen offset:1792 sc1
    buffer_load_dword v20, v3, s[8:11], s93 offen offset:2048 sc1
    buffer_load_dword v21, v3, s[8:11], s93 offen offset:2304 sc1
    buffer_load_dword v22, v3, s[8:11], s93 offen offset:2560 sc1
    buffer_load_dword v23, v3, s[8:11], s93 offen offset:2816 sc1
    buffer_load_dword v24, v3, s[8:11], s93 offen offset:3072 sc1
    buffer_load_dword v25, v3, s[8:11], s93 offen offset:3328 sc1
    buffer_load_dword v26, v3, s[8:11], s93 offen offset:3584 sc1
    buffer_load_dword v27, v3, s[8:11], s93 offen offset:3840 sc1
    s_waitcnt vmcnt(22)
    s_barrier
    s_add_u32 s93, s93, 4096
    buffer_load_dword v28, v3, s[8:11], s93 offen offset:0 sc1
    buffer_load_dword v29, v3, s[8:11], s93 offen offset:256 sc1
    buffer_load_dword v30, v3, s[8:11], s93 offen offset:512 sc1
    buffer_load_dword v31, v3, s[8:11], s93 offen offset:768 sc1
    buffer_load_dword v32, v3, s[8:11], s93 offen offset:1024 sc1
    buffer_load_dword v33, v3, s[8:11], s93 offen offset:1280 sc1
    buffer_load_dword v34, v3, s[8:11], s93 offen offset:1536 sc1
    buffer_load_dword v35, v3, s[8:11], s93 offen offset:1792 sc1
    buffer_load_dword v36, v3, s[8:11], s93 offen offset:2048 sc1
    buffer_load_dword v37, v3, s[8:11], s93 offen offset:2304 sc1
    buffer_load_dword v38, v3, s[8:11], s93 offen offset:2560 sc1
    buffer_load_dword v39, v3, s[8:11], s93 offen offset:2816 sc1
    buffer_load_dword v40, v3, s[8:11], s93 offen offset:3072 sc1
    buffer_load_dword v41, v3, s[8:11], s93 offen offset:3328 sc1
    buffer_load_dword v42, v3, s[8:11], s93 offen offset:3584 sc1
    buffer_load_dword v43, v3, s[8:11], s93 offen offset:3840 sc1
    s_add_u32 s93, s93, 4096
    buffer_load_dword v44, v3, s[8:11], s93 offen offset:0 sc1
    buffer_load_dword v45, v3, s[8:11], s93 offen offset:256 sc1
    buffer_load_dword v46, v3, s[8:11], s93 offen offset:512 sc1
    buffer_load_dword v47, v3, s[8:11], s93 offen offset:768 sc1
    buffer_load_dword v48, v3, s[8:11], s93 offen offset:1024 sc1
    buffer_load_dword v49, v3, s[8:11], s93 offen offset:1280 sc1
    buffer_load_dword v50, v3, s[8:11], s93 offen offset:1536 sc1
    buffer_load_dword v51, v3, s[8:11], s93 offen offset:1792 sc1
    buffer_load_dword v52, v3, s[8:11], s93 offen offset:2048 sc1
    buffer_load_dword v53, v3, s[8:11], s93 offen offset:2304 sc1
    buffer_load_dword v54, v3, s[8:11], s93 offen offset:2560 sc1
    buffer_load_dword v55, v3, s[8:11], s93 offen offset:2816 sc1
    buffer_load_dword v56, v3, s[8:11], s93 offen offset:3072 sc1
    buffer_load_dword v57, v3, s[8:11], s93 offen offset:3328 sc1
    buffer_load_dword v58, v3, s[8:11], s93 offen offset:3584 sc1
    buffer_load_dword v59, v3, s[8:11], s93 offen offset:3840 sc1
    s_waitcnt vmcnt(52)
    s_barrier
    s_waitcnt vmcnt(48)
    s_barrier
    s_add_u32 s93, s93, 4096
    buffer_load_dword v60, v3, s[8:11], s93 offen offset:0 sc1
    buffer_load_dword v61, v3, s[8:11], s93 offen offset:256 sc1
    buffer_load_dword v62, v3, s[8:11], s93 offen offset:512 sc1
    buffer_load_dword v63, v3, s[8:11], s93 offen offset:768 sc1
    buffer_load_dword v64, v3, s[8:11], s93 offen offset:1024 sc1
    buffer_load_dword v65, v3, s[8:11], s93 offen offset:1280 sc1
    buffer_load_dword v66, v3, s[8:11], s93 offen offset:1536 sc1
    buffer_load_dword v67, v3, s[8:11], s93 offen offset:1792 sc1
    buffer_load_dword v68, v3, s[8:11], s93 offen offset:2048 sc1
    buffer_load_dword v69, v3, s[8:11], s93 offen offset:2304 sc1
    s_waitcnt vmcnt(26)
    v_pk_add_f32 v[12:13], v[12:13], v[28:29]
    v_pk_add_f32 v[14:15], v[14:15], v[30:31]
    v_pk_add_f32 v[16:17], v[16:17], v[32:33]
    v_pk_add_f32 v[18:19], v[18:19], v[34:35]
    v_pk_add_f32 v[20:21], v[20:21], v[36:37]
    v_pk_add_f32 v[22:23], v[22:23], v[38:39]
    v_pk_add_f32 v[24:25], v[24:25], v[40:41]
    v_pk_add_f32 v[26:27], v[26:27], v[42:43]
    v_pk_add_f32 v[12:13], v[12:13], v[20:21]
    v_pk_add_f32 v[14:15], v[14:15], v[22:23]
    v_pk_add_f32 v[16:17], v[16:17], v[24:25]
    v_pk_add_f32 v[18:19], v[18:19], v[26:27]
    v_pk_add_f32 v[12:13], v[12:13], v[16:17]
    v_pk_add_f32 v[14:15], v[14:15], v[18:19]
    v_pk_add_f32 v[12:13], v[12:13], v[14:15]
    v_add_f32 v12, v12, v13
    v_mov_b32 v13, v12
    s_nop 1
    v_permlane32_swap_b32 v12, v13
    v_mul_f32 v12, 0x3b000000, v12
    v_mul_f32 v13, 0x3b000000, v13
    v_fma_f32 v13, -v12, v12, v13
    v_max_f32 v13, 0, v13
    v_add_f32 v13, 0x3727c5ac, v13
    v_rsq_f32 v13, v13
    s_nop 0
    v_mul_f32 v13, 0xbfb8aa3b, v13
    v_mul_f32 v12, -v12, v13
    v_mov_b32 v14, v13
    v_mov_b32 v15, v13
    v_mov_b32 v13, v12
    ds_write_b128 v6, v[12:15] offset:0
    v_mov_b32 v11, 163784
    v_mov_b32 v10, 1
    ds_write_b32 v11, v10
    buffer_load_dword v70, v3, s[8:11], s93 offen offset:2560 sc1
    buffer_load_dword v71, v3, s[8:11], s93 offen offset:2816 sc1
    buffer_load_dword v72, v3, s[8:11], s93 offen offset:3072 sc1
    buffer_load_dword v73, v3, s[8:11], s93 offen offset:3328 sc1
    buffer_load_dword v74, v3, s[8:11], s93 offen offset:3584 sc1
    buffer_load_dword v75, v3, s[8:11], s93 offen offset:3840 sc1
    s_waitcnt vmcnt(0)
    v_pk_add_f32 v[44:45], v[44:45], v[60:61]
    v_pk_add_f32 v[46:47], v[46:47], v[62:63]
    v_pk_add_f32 v[48:49], v[48:49], v[64:65]
    v_pk_add_f32 v[50:51], v[50:51], v[66:67]
    v_pk_add_f32 v[52:53], v[52:53], v[68:69]
    v_pk_add_f32 v[54:55], v[54:55], v[70:71]
    v_pk_add_f32 v[56:57], v[56:57], v[72:73]
    v_pk_add_f32 v[58:59], v[58:59], v[74:75]
    v_pk_add_f32 v[44:45], v[44:45], v[52:53]
    v_pk_add_f32 v[46:47], v[46:47], v[54:55]
    v_pk_add_f32 v[48:49], v[48:49], v[56:57]
    v_pk_add_f32 v[50:51], v[50:51], v[58:59]
    v_pk_add_f32 v[44:45], v[44:45], v[48:49]
    v_pk_add_f32 v[46:47], v[46:47], v[50:51]
    v_pk_add_f32 v[44:45], v[44:45], v[46:47]
    v_add_f32 v44, v44, v45
    v_mov_b32 v45, v44
    s_nop 1
    v_permlane32_swap_b32 v44, v45
    v_mul_f32 v44, 0x3b000000, v44
    v_mul_f32 v45, 0x3b000000, v45
    v_fma_f32 v45, -v44, v44, v45
    v_max_f32 v45, 0, v45
    v_add_f32 v45, 0x3727c5ac, v45
    v_rsq_f32 v45, v45
    s_nop 0
    v_mul_f32 v45, 0xbfb8aa3b, v45
    v_mul_f32 v44, -v44, v45
    v_mov_b32 v46, v45
    v_mov_b32 v47, v45
    v_mov_b32 v45, v44
    ds_write_b128 v6, v[44:47] offset:512
    v_mov_b32 v11, 163784
    v_mov_b32 v10, 2
    ds_write_b32 v11, v10
    buffer_load_dwordx4 a[0:3], v2, s[8:11], s44 offen offset:0 sc1
    buffer_load_dwordx4 a[4:7], v2, s[8:11], s44 offen offset:1024 sc1
    buffer_load_dwordx4 a[8:11], v2, s[8:11], s44 offen offset:2048 sc1
    buffer_load_dwordx4 a[12:15], v2, s[8:11], s44 offen offset:3072 sc1
    s_add_u32 s44, s44, 4096
    s_cmp_eq_u32 s44, s36
    s_cselect_b32 s44, s46, s44
    buffer_load_dwordx4 a[16:19], v2, s[8:11], s44 offen offset:0 sc1
    buffer_load_dwordx4 a[20:23], v2, s[8:11], s44 offen offset:1024 sc1
    buffer_load_dwordx4 a[24:27], v2, s[8:11], s44 offen offset:2048 sc1
    buffer_load_dwordx4 a[28:31], v2, s[8:11], s44 offen offset:3072 sc1
    s_add_u32 s44, s44, 4096
    s_cmp_eq_u32 s44, s36
    s_cselect_b32 s44, s46, s44
    buffer_load_dwordx4 a[32:35], v2, s[8:11], s44 offen offset:0 sc1
    buffer_load_dwordx4 a[36:39], v2, s[8:11], s44 offen offset:1024 sc1
    buffer_load_dwordx4 a[40:43], v2, s[8:11], s44 offen offset:2048 sc1
    buffer_load_dwordx4 a[44:47], v2, s[8:11], s44 offen offset:3072 sc1
    s_add_u32 s44, s44, 4096
    s_cmp_eq_u32 s44, s36
    s_cselect_b32 s44, s46, s44
    buffer_load_dwordx4 a[48:51], v2, s[8:11], s44 offen offset:0 sc1
    buffer_load_dwordx4 a[52:55], v2, s[8:11], s44 offen offset:1024 sc1
    buffer_load_dwordx4 a[56:59], v2, s[8:11], s44 offen offset:2048 sc1
    buffer_load_dwordx4 a[60:63], v2, s[8:11], s44 offen offset:3072 sc1
    s_add_u32 s44, s44, 4096
    s_cmp_eq_u32 s44, s36
    s_cselect_b32 s44, s46, s44
    buffer_load_dwordx4 a[64:67], v2, s[8:11], s44 offen offset:0 sc1
    buffer_load_dwordx4 a[68:71], v2, s[8:11], s44 offen offset:1024 sc1
    buffer_load_dwordx4 a[72:75], v2, s[8:11], s44 offen offset:2048 sc1
    buffer_load_dwordx4 a[76:79], v2, s[8:11], s44 offen offset:3072 sc1
    s_add_u32 s44, s44, 4096
    s_cmp_eq_u32 s44, s36
    s_cselect_b32 s44, s46, s44
    buffer_load_dwordx4 a[80:83], v2, s[8:11], s44 offen offset:0 sc1
    buffer_load_dwordx4 a[84:87], v2, s[8:11], s44 offen offset:1024 sc1
    buffer_load_dwordx4 a[88:91], v2, s[8:11], s44 offen offset:2048 sc1
    buffer_load_dwordx4 a[92:95], v2, s[8:11], s44 offen offset:3072 sc1
    s_add_u32 s44, s44, 4096
    s_cmp_eq_u32 s44, s36
    s_cselect_b32 s44, s46, s44
    buffer_load_dwordx4 a[96:99], v2, s[8:11], s44 offen offset:0 sc1
    buffer_load_dwordx4 a[100:103], v2, s[8:11], s44 offen offset:1024 sc1
    buffer_load_dwordx4 a[104:107], v2, s[8:11], s44 offen offset:2048 sc1
    buffer_load_dwordx4 a[108:111], v2, s[8:11], s44 offen offset:3072 sc1
    s_add_u32 s44, s44, 4096
    s_cmp_eq_u32 s44, s36
    s_cselect_b32 s44, s46, s44
L_p4_end:
    s_and_b32 s33, s3, 3
    s_mul_i32 s32, s33, 28672
    s_add_u32 s38, s92, s32
    s_lshl_b32 s32, s37, 10
    s_add_u32 s38, s38, s32
    s_add_u32 s36, s38, 28672
    s_add_u32 s44, s38, s62
    s_lshl_b32 s48, s56, 10
    s_add_u32 s48, s48, 196608
    s_add_u32 s49, s43, 196608
    s_lshl_b32 s33, s33, 1
    s_add_u32 s33, s33, s37
    s_lshl_b32 s39, s33, 10
    s_lshl_b32 s46, s59, 15
    s_lshl_b32 s32, s60, 5
    s_add_u32 s46, s46, s32
    s_waitcnt vmcnt(0)
    s_barrier
    s_cmp_lg_u32 s3, 0
    s_cbranch_scc1 L_p5_a
    s_cmp_eq_u32 s65, 0
    s_cselect_b32 s32, 29229056, 0
    s_add_u32 s48, s48, s32
    s_add_u32 s32, s49, 29229056
    s_add_u32 s32, s32, s65
    s_xor_b32 s33, s65, 1073741824
    s_add_u32 s49, s49, s33
    v_mov_b32 v10, s4
    buffer_store_dword v10, v0, s[8:11], s32 offen
    buffer_store_dword v10, v0, s[8:11], s49 offen sc1
L_p5_a:
    s_cmp_lg_u32 s3, 0
    s_cbranch_scc1 L_p5_b
    s_mov_b32 exec_lo, 0xff
    s_mov_b32 exec_hi, 0x0
    s_mov_b32 s33, 0
L_poll_26:
    buffer_load_dword v10, v126, s[8:11], s48 offen sc1
    s_waitcnt vmcnt(0)
    v_cmp_ne_u32 vcc, s4, v10
    s_cbranch_vccz L_got_27
    s_add_u32 s33, s33, 1
    s_cmp_lt_u32 s33, 100000
    s_cbranch_scc1 L_poll_26
L_got_27:
    s_mov_b64 exec, -1
L_p5_b:
    s_barrier
    s_add_u32 m0, s39, 0
    s_nop 0
    buffer_load_dwordx4 v2, s[8:11], s44 offen offset:0 sc1 lds
    s_add_u32 m0, s39, 6144
    s_nop 0
    buffer_load_dwordx4 v2, s[8:11], s44 offen offset:2048 sc1 lds
    s_add_u32 s44, s44, 4096
    s_cmp_eq_u32 s44, s36
    s_cselect_b32 s44, s38, s44
    s_barrier
    s_add_u32 m0, s39, 16384
    s_nop 0
    buffer_load_dwordx4 v2, s[8:11], s44 offen offset:0 sc1 lds
    s_add_u32 m0, s39, 22528
    s_nop 0
    buffer_load_dwordx4 v2, s[8:11], s44 offen offset:2048 sc1 lds
    s_add_u32 s44, s44, 4096
    s_cmp_eq_u32 s44, s36
    s_cselect_b32 s44, s38, s44
    s_waitcnt vmcnt(2)
    s_barrier
    ds_read_b128 v[64:67], v112 offset:0
    ds_read_b128 v[68:71], v112 offset:1024
    ds_read_b128 v[72:75], v112 offset:8192
    ds_read_b128 v[76:79], v112 offset:9216
    s_add_u32 m0, s39, 32768
    s_nop 0
    buffer_load_dwordx4 v2, s[8:11], s44 offen offset:0 sc1 lds
    s_add_u32 m0, s39, 38912
    s_nop 0
    buffer_load_dwordx4 v2, s[8:11], s44 offen offset:2048 sc1 lds
    s_add_u32 s44, s44, 4096
    s_cmp_eq_u32 s44, s36
    s_cselect_b32 s44, s38, s44
    s_waitcnt vmcnt(2)
    s_barrier
    s_waitcnt lgkmcnt(0)
    v_mfma_f32_32x32x16_bf16 v[32:47], a[0:3], v[64:67], 0
    ds_read_b128 v[80:83], v112 offset:16384
    ds_read_b128 v[84:87], v112 offset:17408
    v_mfma_f32_32x32x16_bf16 v[32:47], a[4:7], v[68:71], v[32:47]
    ds_read_b128 v[88:91], v112 offset:24576
    ds_read_b128 v[92:95], v112 offset:25600
    s_add_u32 m0, s39, 49152
    s_nop 0
    buffer_load_dwordx4 v2, s[8:11], s44 offen offset:0 sc1 lds
    v_mfma_f32_32x32x16_bf16 v[32:47], a[8:11], v[72:75], v[32:47]
    s_add_u32 m0, s39, 55296
    s_nop 0
    buffer_load_dwordx4 v2, s[8:11], s44 offen offset:2048 sc1 lds
    s_add_u32 s44, s44, 4096
    s_cmp_eq_u32 s44, s36
    s_cselect_b32 s44, s38, s44
    v_mfma_f32_32x32x16_bf16 v[32:47], a[12:15], v[76:79], v[32:47]
    s_waitcnt vmcnt(2)
    s_barrier
    s_waitcnt lgkmcnt(0)
    v_mfma_f32_32x32x16_bf16 v[32:47], a[16:19], v[80:83], v[32:47]
    ds_read_b128 v[64:67], v112 offset:32768
    ds_read_b128 v[68:71], v112 offset:33792
    v_mfma_f32_32x32x16_bf16 v[32:47], a[20:23], v[84:87], v[32:47]
    ds_read_b128 v[72:75], v112 offset:40960
    ds_read_b128 v[76:79], v112 offset:41984
    s_add_u32 m0, s39, 65536
    s_nop 0
    buffer_load_dwordx4 v2, s[8:11], s44 offen offset:0 sc1 lds
    v_mfma_f32_32x32x16_bf16 v[32:47], a[24:27], v[88:91], v[32:47]
    s_add_u32 m0, s39, 71680
    s_nop 0
    buffer_load_dwordx4 v2, s[8:11], s44 offen offset:2048 sc1 lds
    s_add_u32 s44, s44, 4096
    s_cmp_eq_u32 s44, s36
    s_cselect_b32 s44, s38, s44
    v_mfma_f32_32x32x16_bf16 v[32:47], a[28:31], v[92:95], v[32:47]
    s_waitcnt vmcnt(2)
    s_barrier
    s_waitcnt lgkmcnt(0)
    v_mfma_f32_32x32x16_bf16 v[32:47], a[32:35], v[64:67], v[32:47]
    ds_read_b128 v[80:83], v113 offset:0
    ds_read_b128 v[84:87], v113 offset:1024
    v_mfma_f32_32x32x16_bf16 v[32:47], a[36:39], v[68:71], v[32:47]
    ds_read_b128 v[88:91], v113 offset:8192
    ds_read_b128 v[92:95], v113 offset:9216
    s_add_u32 m0, s39, 81920
    s_nop 0
    buffer_load_dwordx4 v2, s[8:11], s44 offen offset:0 sc1 lds
    v_mfma_f32_32x32x16_bf16 v[32:47], a[40:43], v[72:75], v[32:47]
    s_add_u32 m0, s39, 88064
    s_nop 0
    buffer_load_dwordx4 v2, s[8:11], s44 offen offset:2048 sc1 lds
    s_add_u32 s44, s44, 4096
    s_cmp_eq_u32 s44, s36
    s_cselect_b32 s44, s38, s44
    v_mfma_f32_32x32x16_bf16 v[32:47], a[44:47], v[76:79], v[32:47]
    s_waitcnt vmcnt(2)
    s_barrier
    s_waitcnt lgkmcnt(0)
    v_mfma_f32_32x32x16_bf16 v[32:47], a[48:51], v[80:83], v[32:47]
    ds_read_b128 v[64:67], v113 offset:16384
    ds_read_b128 v[68:71], v113 offset:17408
    v_mfma_f32_32x32x16_bf16 v[32:47], a[52:55], v[84:87], v[32:47]
    ds_read_b128 v[72:75], v113 offset:24576
    ds_read_b128 v[76:79], v113 offset:25600
    s_add_u32 m0, s39, 0
    s_nop 0
    buffer_load_dwordx4 v2, s[8:11], s44 offen offset:0 sc1 lds
    v_mfma_f32_32x32x16_bf16 v[32:47], a[56:59], v[88:91], v[32:47]
    s_add_u32 m0, s39, 6144
    s_nop 0
    buffer_load_dwordx4 v2, s[8:11], s44 offen offset:2048 sc1 lds
    s_add_u32 s44, s44, 4096
    s_cmp_eq_u32 s44, s36
    s_cselect_b32 s44, s38, s44
    v_mfma_f32_32x32x16_bf16 v[32:47], a[60:63], v[92:95], v[32:47]
    s_waitcnt vmcnt(2)
    s_barrier
    s_waitcnt lgkmcnt(0)
    v_mfma_f32_32x32x16_bf16 v[32:47], a[64:67], v[64:67], v[32:47]
    ds_read_b128 v[80:83], v113 offset:32768
    ds_read_b128 v[84:87], v113 offset:33792
    v_mfma_f32_32x32x16_bf16 v[32:47], a[68:71], v[68:71], v[32:47]
    ds_read_b128 v[88:91], v113 offset:40960
    ds_read_b128 v[92:95], v113 offset:41984
    s_add_u32 s38, s38, 114688
    s_add_u32 s44, s44, 114688
    s_add_u32 s36, s36, 114688
    s_add_u32 m0, s39, 16384
    s_nop 0
    buffer_load_dwordx4 v2, s[8:11], s44 offen offset:0 sc1 lds
    v_mfma_f32_32x32x16_bf16 v[32:47], a[72:75], v[72:75], v[32:47]
    s_add_u32 m0, s39, 22528
    s_nop 0
    buffer_load_dwordx4 v2, s[8:11], s44 offen offset:2048 sc1 lds
    s_add_u32 s44, s44, 4096
    s_cmp_eq_u32 s44, s36
    s_cselect_b32 s44, s38, s44
    v_mfma_f32_32x32x16_bf16 v[32:47], a[76:79], v[76:79], v[32:47]
    s_waitcnt vmcnt(2)
    s_barrier
    s_waitcnt lgkmcnt(0)
    v_mfma_f32_32x32x16_bf16 v[32:47], a[80:83], v[80:83], v[32:47]
    ds_read_b128 v[64:67], v112 offset:0
    ds_read_b128 v[68:71], v112 offset:1024
    v_mfma_f32_32x32x16_bf16 v[32:47], a[84:87], v[84:87], v[32:47]
    ds_read_b128 v[72:75], v112 offset:8192
    ds_read_b128 v[76:79], v112 offset:9216
    s_add_u32 m0, s39, 32768
    s_nop 0
    buffer_load_dwordx4 v2, s[8:11], s44 offen offset:0 sc1 lds
    v_mfma_f32_32x32x16_bf16 v[32:47], a[88:91], v[88:91], v[32:47]
    s_add_u32 m0, s39, 38912
    s_nop 0
    buffer_load_dwordx4 v2, s[8:11], s44 offen offset:2048 sc1 lds
    s_add_u32 s44, s44, 4096
    s_cmp_eq_u32 s44, s36
    s_cselect_b32 s44, s38, s44
    v_mfma_f32_32x32x16_bf16 v[32:47], a[92:95], v[92:95], v[32:47]
    s_waitcnt vmcnt(2)
    s_barrier
    s_waitcnt lgkmcnt(0)
    v_mfma_f32_32x32x16_bf16 v[32:47], a[96:99], v[64:67], v[32:47]
    ds_read_b128 v[80:83], v112 offset:16384
    ds_read_b128 v[84:87], v112 offset:17408
    v_mfma_f32_32x32x16_bf16 v[32:47], a[100:103], v[68:71], v[32:47]
    ds_read_b128 v[88:91], v112 offset:24576
    ds_read_b128 v[92:95], v112 offset:25600
    s_add_u32 m0, s39, 49152
    s_nop 0
    buffer_load_dwordx4 v2, s[8:11], s44 offen offset:0 sc1 lds
    v_mfma_f32_32x32x16_bf16 v[32:47], a[104:107], v[72:75], v[32:47]
    s_add_u32 m0, s39, 55296
    s_nop 0
    buffer_load_dwordx4 v2, s[8:11], s44 offen offset:2048 sc1 lds
    s_add_u32 s44, s44, 4096
    s_cmp_eq_u32 s44, s36
    s_cselect_b32 s44, s38, s44
    v_mfma_f32_32x32x16_bf16 v[32:47], a[108:111], v[76:79], v[32:47]
    s_waitcnt vmcnt(2)
    s_barrier
    s_waitcnt lgkmcnt(0)
    v_mfma_f32_32x32x16_bf16 v[48:63], a[0:3], v[80:83], 0
    ds_read_b128 v[64:67], v112 offset:32768
    ds_read_b128 v[68:71], v112 offset:33792
    v_mfma_f32_32x32x16_bf16 v[48:63], a[4:7], v[84:87], v[48:63]
    ds_read_b128 v[72:75], v112 offset:40960
    ds_read_b128 v[76:79], v112 offset:41984
    s_add_u32 m0, s39, 65536
    s_nop 0
    buffer_load_dwordx4 v2, s[8:11], s44 offen offset:0 sc1 lds
    v_mfma_f32_32x32x16_bf16 v[48:63], a[8:11], v[88:91], v[48:63]
    s_add_u32 m0, s39, 71680
    s_nop 0
    buffer_load_dwordx4 v2, s[8:11], s44 offen offset:2048 sc1 lds
    s_add_u32 s44, s44, 4096
    s_cmp_eq_u32 s44, s36
    s_cselect_b32 s44, s38, s44
    v_mfma_f32_32x32x16_bf16 v[48:63], a[12:15], v[92:95], v[48:63]
    s_waitcnt vmcnt(2)
    s_barrier
    s_waitcnt lgkmcnt(0)
    v_mfma_f32_32x32x16_bf16 v[48:63], a[16:19], v[64:67], v[48:63]
    ds_read_b128 v[80:83], v113 offset:0
    ds_read_b128 v[84:87], v113 offset:1024
    v_mfma_f32_32x32x16_bf16 v[48:63], a[20:23], v[68:71], v[48:63]
    ds_read_b128 v[88:91], v113 offset:8192
    ds_read_b128 v[92:95], v113 offset:9216
    s_add_u32 m0, s39, 81920
    s_nop 0
    buffer_load_dwordx4 v2, s[8:11], s44 offen offset:0 sc1 lds
    v_mfma_f32_32x32x16_bf16 v[48:63], a[24:27], v[72:75], v[48:63]
    s_add_u32 m0, s39, 88064
    s_nop 0
    buffer_load_dwordx4 v2, s[8:11], s44 offen offset:2048 sc1 lds
    s_add_u32 s44, s44, 4096
    s_cmp_eq_u32 s44, s36
    s_cselect_b32 s44, s38, s44
    v_mfma_f32_32x32x16_bf16 v[48:63], a[28:31], v[76:79], v[48:63]
    s_waitcnt vmcnt(2)
    s_barrier
    s_waitcnt lgkmcnt(0)
    v_mfma_f32_32x32x16_bf16 v[48:63], a[32:35], v[80:83], v[48:63]
    ds_read_b128 v[64:67], v113 offset:16384
    ds_read_b128 v[68:71], v113 offset:17408
    v_mfma_f32_32x32x16_bf16 v[48:63], a[36:39], v[84:87], v[48:63]
    ds_read_b128 v[72:75], v113 offset:24576
    ds_read_b128 v[76:79], v113 offset:25600
    s_add_u32 m0, s39, 0
    s_nop 0
    buffer_load_dwordx4 v2, s[8:11], s44 offen offset:0 sc1 lds
    v_mfma_f32_32x32x16_bf16 v[48:63], a[40:43], v[88:91], v[48:63]
    s_add_u32 m0, s39, 6144
    s_nop 0
    buffer_load_dwordx4 v2, s[8:11], s44 offen offset:2048 sc1 lds
    s_add_u32 s44, s44, 4096
    s_cmp_eq_u32 s44, s36
    s_cselect_b32 s44, s38, s44
    v_mfma_f32_32x32x16_bf16 v[48:63], a[44:47], v[92:95], v[48:63]
    s_waitcnt vmcnt(2)
    s_barrier
    s_waitcnt lgkmcnt(0)
    v_mfma_f32_32x32x16_bf16 v[48:63], a[48:51], v[64:67], v[48:63]
    ds_read_b128 v[80:83], v113 offset:32768
    ds_read_b128 v[84:87], v113 offset:33792
    v_mfma_f32_32x32x16_bf16 v[48:63], a[52:55], v[68:71], v[48:63]
    ds_read_b128 v[88:91], v113 offset:40960
    ds_read_b128 v[92:95], v113 offset:41984
    s_add_u32 m0, s39, 16384
    s_nop 0
    buffer_load_dwordx4 v2, s[8:11], s44 offen offset:0 sc1 lds
    v_mfma_f32_32x32x16_bf16 v[48:63], a[56:59], v[72:75], v[48:63]
    s_add_u32 m0, s39, 22528
    s_nop 0
    buffer_load_dwordx4 v2, s[8:11], s44 offen offset:2048 sc1 lds
    s_add_u32 s44, s44, 4096
    s_cmp_eq_u32 s44, s36
    s_cselect_b32 s44, s38, s44
    v_mfma_f32_32x32x16_bf16 v[48:63], a[60:63], v[76:79], v[48:63]
    s_waitcnt vmcnt(2)
    s_barrier
    s_waitcnt lgkmcnt(0)
    v_mfma_f32_32x32x16_bf16 v[48:63], a[64:67], v[80:83], v[48:63]
    ds_read_b128 v[64:67], v112 offset:0
    ds_read_b128 v[68:71], v112 offset:1024
    v_mfma_f32_32x32x16_bf16 v[48:63], a[68:71], v[84:87], v[48:63]
    ds_read_b128 v[72:75], v112 offset:8192
    ds_read_b128 v[76:79], v112 offset:9216
    v_mfma_f32_32x32x16_bf16 v[48:63], a[72:75], v[88:91], v[48:63]
    v_mfma_f32_32x32x16_bf16 v[48:63], a[76:79], v[92:95], v[48:63]
    s_waitcnt vmcnt(0)
    s_barrier
    s_waitcnt lgkmcnt(0)
    v_mfma_f32_32x32x16_bf16 v[48:63], a[80:83], v[64:67], v[48:63]
    ds_read_b128 v[80:83], v112 offset:16384
    ds_read_b128 v[84:87], v112 offset:17408
    ds_write_b128 v114, v[32:35] offset:0
    ds_write_b128 v114, v[36:39] offset:1024
    v_mfma_f32_32x32x16_bf16 v[48:63], a[84:87], v[68:71], v[48:63]
    ds_read_b128 v[88:91], v112 offset:24576
    ds_read_b128 v[92:95], v112 offset:25600
    ds_write_b128 v114, v[40:43] offset:8192
    ds_write_b128 v114, v[44:47] offset:9216
    v_mfma_f32_32x32x16_bf16 v[48:63], a[88:91], v[72:75], v[48:63]
    v_mfma_f32_32x32x16_bf16 v[48:63], a[92:95], v[76:79], v[48:63]
    s_waitcnt lgkmcnt(7)
    v_mfma_f32_32x32x16_bf16 v[48:63], a[96:99], v[80:83], v[48:63]
    s_waitcnt lgkmcnt(6)
    v_mfma_f32_32x32x16_bf16 v[48:63], a[100:103], v[84:87], v[48:63]
    s_waitcnt lgkmcnt(3)
    v_mfma_f32_32x32x16_bf16 v[48:63], a[104:107], v[88:91], v[48:63]
    s_waitcnt lgkmcnt(2)
    v_mfma_f32_32x32x16_bf16 v[48:63], a[108:111], v[92:95], v[48:63]
    v_lshlrev_b32 v12, 16, v96
    v_and_b32 v13, 0xffff0000, v96
    v_lshlrev_b32 v14, 16, v97
    v_and_b32 v15, 0xffff0000, v97
    v_lshlrev_b32 v16, 16, v98
    v_and_b32 v17, 0xffff0000, v98
    v_lshlrev_b32 v18, 16, v99
    v_and_b32 v19, 0xffff0000, v99
    v_lshlrev_b32 v20, 16, v104
    v_and_b32 v21, 0xffff0000, v104
    v_lshlrev_b32 v22, 16, v105
    v_and_b32 v23, 0xffff0000, v105
    v_lshlrev_b32 v24, 16, v106
    v_and_b32 v25, 0xffff0000, v106
    v_lshlrev_b32 v26, 16, v107
    v_and_b32 v27, 0xffff0000, v107
    ds_write_b128 v114, v[48:51] offset:32768
    ds_write_b128 v114, v[52:55] offset:33792
    ds_write_b128 v114, v[56:59] offset:40960
    ds_write_b128 v114, v[60:63] offset:41984
    v_mul_f32 v20, 0xbf317218, v20
    v_mul_f32 v21, 0xbf317218, v21
    v_mul_f32 v22, 0xbf317218, v22
    v_mul_f32 v23, 0xbf317218, v23
    v_mul_f32 v24, 0xbf317218, v24
    v_mul_f32 v25, 0xbf317218, v25
    v_mul_f32 v26, 0xbf317218, v26
    v_mul_f32 v27, 0xbf317218, v27
    s_waitcnt lgkmcnt(0)
    s_barrier
    ds_read_b128 v[64:67], v115 offset:0
    ds_read_b128 v[68:71], v115 offset:1024
    ds_read_b128 v[72:75], v115 offset:2048
    ds_read_b128 v[76:79], v115 offset:3072
    ds_read_b128 v[80:83], v115 offset:4096
    ds_read_b128 v[84:87], v115 offset:5120
    ds_read_b128 v[88:91], v115 offset:6144
    ds_read_b128 v[92:95], v115 offset:7168
    s_waitcnt lgkmcnt(4)
    v_pk_add_f32 v[64:65], v[64:65], v[72:73]
    v_pk_add_f32 v[66:67], v[66:67], v[74:75]
    v_pk_add_f32 v[68:69], v[68:69], v[76:77]
    v_pk_add_f32 v[70:71], v[70:71], v[78:79]
    s_waitcnt lgkmcnt(0)
    v_pk_add_f32 v[80:81], v[80:81], v[88:89]
    v_pk_add_f32 v[82:83], v[82:83], v[90:91]
    v_pk_add_f32 v[84:85], v[84:85], v[92:93]
    v_pk_add_f32 v[86:87], v[86:87], v[94:95]
    v_pk_add_f32 v[64:65], v[64:65], v[80:81]
    v_pk_add_f32 v[66:67], v[66:67], v[82:83]
    v_pk_add_f32 v[68:69], v[68:69], v[84:85]
    v_pk_add_f32 v[70:71], v[70:71], v[86:87]
    v_pk_fma_f32 v[64:65], v[64:65], v[20:21], v[12:13]
    v_pk_fma_f32 v[66:67], v[66:67], v[22:23], v[14:15]
    v_pk_fma_f32 v[68:69], v[68:69], v[24:25], v[16:17]
    v_pk_fma_f32 v[70:71], v[70:71], v[26:27], v[18:19]
    v_cvt_pk_bf16_f32 v96, v64, v65
    v_cvt_pk_bf16_f32 v97, v66, v67
    v_cvt_pk_bf16_f32 v98, v68, v69
    v_cvt_pk_bf16_f32 v99, v70, v71
    s_nop 1
    v_permlane32_swap_b32 v96, v98
    v_permlane32_swap_b32 v97, v99
    buffer_store_dwordx4 v[96:99], v124, s[28:31], s46 offen
    s_waitcnt vmcnt(0)
    s_endpgm
L_end:
    s_endpgm
L_gs_13:
    s_mov_b32 s33, 0
L_gs_13_a:
    s_sleep 16
    buffer_load_dwordx2 v[110:111], v114, s[8:11], s94 offen sc1
    s_add_u32 s33, s33, 1
    s_waitcnt vmcnt(0)
    v_cmp_ne_u32 vcc, s4, v111
    s_and_b64 vcc, vcc, 0xffff
    s_cbranch_vccz L_gsok_14
    s_cmp_lt_u32 s33, 100000
    s_cbranch_scc1 L_gs_13_a
    s_branch L_gsok_14
L_ck_15:
    s_mov_b32 s33, 0
L_ck_15_a:
    s_sleep 16
    buffer_load_dwordx2 v[112:113], v8, s[8:11], 0 offen sc1
    s_add_u32 s33, s33, 1
    s_waitcnt vmcnt(0)
    v_cmp_ne_u32 vcc, s4, v113
    s_and_b64 vcc, vcc, s[100:101]
    s_cbranch_vccz L_ckok_16
    s_cmp_lt_u32 s33, 100000
    s_cbranch_scc1 L_ck_15_a
    s_branch L_ckok_16
L_fallback:
    s_lshl_b32 s34, s76, 16
    s_add_u32 s33, s34, 5242880
    v_mov_b32 v10, 0xff800000
    s_mov_b32 s32, 64
L_fb1:
    buffer_load_dwordx4 v[20:23], v2, s[8:11], s33 offen sc1
    s_add_u32 s33, s33, 1024
    s_waitcnt vmcnt(0)
    v_mfma_f32_32x32x16_bf16 v[32:47], v[20:23], v[12:15], 0
    s_nop 11
    v_max3_f32 v10, v10, v32, v33
    v_max3_f32 v10, v10, v34, v35
    v_max3_f32 v10, v10, v36, v37
    v_max3_f32 v10, v10, v38, v39
    v_max3_f32 v10, v10, v40, v41
    v_max3_f32 v10, v10, v42, v43
    v_max3_f32 v10, v10, v44, v45
    v_max3_f32 v10, v10, v46, v47
    s_sub_u32 s32, s32, 1
    s_cmp_lg_u32 s32, 0
    s_cbranch_scc1 L_fb1
    v_mov_b32 v11, v10
    s_nop 1
    v_permlane32_swap_b32 v10, v11
    v_max_f32 v10, v10, v11
    v_sub_f32 v48, 0, v10
    v_mov_b32 v64, 0
    v_sub_f32 v49, 0, v10
    v_mov_b32 v65, 0
    v_sub_f32 v50, 0, v10
    v_mov_b32 v66, 0
    v_sub_f32 v51, 0, v10
    v_mov_b32 v67, 0
    v_sub_f32 v52, 0, v10
    v_mov_b32 v68, 0
    v_sub_f32 v53, 0, v10
    v_mov_b32 v69, 0
    v_sub_f32 v54, 0, v10
    v_mov_b32 v70, 0
    v_sub_f32 v55, 0, v10
    v_mov_b32 v71, 0
    v_sub_f32 v56, 0, v10
    v_mov_b32 v72, 0
    v_sub_f32 v57, 0, v10
    v_mov_b32 v73, 0
    v_sub_f32 v58, 0, v10
    v_mov_b32 v74, 0
    v_sub_f32 v59, 0, v10
    v_mov_b32 v75, 0
    v_sub_f32 v60, 0, v10
    v_mov_b32 v76, 0
    v_sub_f32 v61, 0, v10
    v_mov_b32 v77, 0
    v_sub_f32 v62, 0, v10
    v_mov_b32 v78, 0
    v_sub_f32 v63, 0, v10
    v_mov_b32 v79, 0
    v_mov_b32 v24, 0x3f803f80
    v_mov_b32 v25, 0x3f803f80
    v_mov_b32 v26, 0x3f803f80
    v_mov_b32 v27, 0x3f803f80
    v_mov_b32 v28, 0x3f803f80
    v_mov_b32 v29, 0x3f803f80
    v_mov_b32 v30, 0x3f803f80
    v_mov_b32 v31, 0x3f803f80
    v_and_b32 v10, 15, v1
    v_lshlrev_b32 v11, 4, v7
    v_lshl_add_u32 v11, v10, 4, v11
    s_add_u32 s33, s34, 5242880
    s_add_u32 s35, s34, 7340032
    s_mov_b32 s32, 64
L_fb2:
    buffer_load_dwordx4 v[20:23], v2, s[8:11], s33 offen sc1
    s_mov_b32 exec_lo, 0xffff
    s_mov_b32 exec_hi, 0xffff
    buffer_load_dwordx4 v[24:27], v11, s[8:11], s35 offen sc1
    buffer_load_dwordx4 v[28:31], v11, s[8:11], s35 offen offset:512 sc1
    s_mov_b64 exec, -1
    s_add_u32 s33, s33, 1024
    s_add_u32 s35, s35, 1024
    s_waitcnt vmcnt(0)
    v_mfma_f32_32x32x16_bf16 v[32:47], v[20:23], v[12:15], v[48:63]
    s_nop 11
    v_exp_f32 v32, v32
    v_exp_f32 v33, v33
    v_exp_f32 v34, v34
    v_exp_f32 v35, v35
    v_exp_f32 v36, v36
    v_exp_f32 v37, v37
    v_exp_f32 v38, v38
    v_exp_f32 v39, v39
    v_exp_f32 v40, v40
    v_exp_f32 v41, v41
    v_exp_f32 v42, v42
    v_exp_f32 v43, v43
    v_exp_f32 v44, v44
    v_exp_f32 v45, v45
    v_exp_f32 v46, v46
    v_exp_f32 v47, v47
    s_nop 1
    v_smfmac_f32_32x32x32_bf16 v[64:79], v[24:27], v[32:39], v9
    v_smfmac_f32_32x32x32_bf16 v[64:79], v[28:31], v[40:47], v9
    s_sub_u32 s32, s32, 1
    s_cmp_lg_u32 s32, 0
    s_cbranch_scc1 L_fb2
    s_nop 11
    s_branch L_fb_ret
L_codeend:
.section .rodata,"a"
.p2align 6
.amdhsa_kernel adaLN_cond__softmax_full_mha__dense_activation_silu__prompt_kernel
  .amdhsa_next_free_vgpr 256
  .amdhsa_next_free_sgpr 102
  .amdhsa_accum_offset 128
  .amdhsa_group_segment_fixed_size 0
  .amdhsa_kernarg_size 88
  .amdhsa_user_sgpr_count 2
  .amdhsa_user_sgpr_kernarg_segment_ptr 1
  .amdhsa_system_sgpr_workgroup_id_x 1
.end_amdhsa_kernel
```
